```python
import torch

def _softmax(x, axis=-1):
    return torch.softmax(x, dim=axis)

def _gelu(x):
    return torch.nn.functional.gelu(x, approximate='tanh')

def _silu(x):
    return torch.nn.functional.silu(x)

def _sigmoid(x):
    return torch.sigmoid(x)

def _layernorm(x, axis=-1, eps=1e-05):
    m = x.mean(dim=axis, keepdim=True)
    v = x.var(dim=axis, keepdim=True, unbiased=False)
    return (x - m) / torch.sqrt(v + eps)

def _scatter_add(tgt, idx, src, axis=0):
    return tgt.clone().index_add_(axis, idx, src)

def _segment_sum(src, seg, n):
    out = torch.zeros((n,) + src.shape[1:], dtype=src.dtype)
    return out.index_add_(0, seg, src)

def _pad(x, pw):
    flat = tuple((v for pair in reversed(pw) for v in pair))
    return torch.nn.functional.pad(x, flat)
kernel_name = 'standalone__tensor_product_equiv_equiformer__graph'

def setup_inputs():

    _w = lambda a: (lambda t: t.to(torch.bfloat16) if t.is_floating_point() else t)(torch.as_tensor(a))
    N, deg, C, De = (10000, 64, 64, max(0, 1))
    E = N * deg
    src = (lambda lo, hi, *s: torch.randint(lo, hi, s))(0, N, E).to(torch.int64)
    dst = (lambda lo, hi, *s: torch.randint(lo, hi, s))(0, N, E).to(torch.int64)
    rvec = (lambda *s: torch.randn(*s, dtype=torch.bfloat16) * 0.05)(E, 3).to(float)
    rn = (torch.linalg.norm(rvec, dim=-1, keepdim=True) + 1e-06).to(float)
    rhat = (rvec / rn).to(float)
    eps = torch.zeros((3, 3, 3), dtype=float)
    eps[0, 1, 2] = eps[1, 2, 0] = eps[2, 0, 1] = 1.0
    eps[0, 2, 1] = eps[2, 1, 0] = eps[1, 0, 2] = -1.0
    return {'x': _w((lambda *s: torch.randn(*s, dtype=torch.bfloat16) * 0.4)(N, 4 * C).to(float)), 'rhat': _w(rhat), 'e_attr': _w((lambda *s: torch.randn(*s, dtype=torch.bfloat16) * 0.4)(E, De).to(float)), 'src': _w(src), 'dst': _w(dst), 'w_rad': _w((lambda *s: torch.randn(*s, dtype=torch.bfloat16) * 0.4)(De, 5 * C).to(float)), 'w_si0': _w((lambda *s: torch.randn(*s, dtype=torch.bfloat16) * 0.4)(2 * C, C).to(float)), 'w_si1': _w((lambda *s: torch.randn(*s, dtype=torch.bfloat16) * 0.05)(3 * C, C).to(float)), 'cg_eps': _w(eps)}

def reference(x, rhat, e_attr, src, dst, w_rad, w_si0, w_si1, cg_eps):
    N = x.shape[0]
    C = w_si0.shape[1]
    E = rhat.shape[0]
    x0 = x[:, :C].clone()
    x1 = x[:, C:].reshape(N, 3, C)
    R = (e_attr @ w_rad).reshape(E, 5, C)
    f0 = x0[src]
    f1 = x1[src]
    Y1 = rhat
    p00_0 = f0 * R[:, 0, :]
    p11_0 = torch.einsum('ejc,ej->ec', f1, Y1) * R[:, 1, :]
    p01_1 = torch.einsum('ec,ej->ejc', f0, Y1) * R[:, 2, :][:, None, :]
    p10_1 = f1 * R[:, 3, :][:, None, :]
    p11_1 = torch.einsum('ijk,ekc,ej->eic', cg_eps, f1, Y1) * R[:, 4, :][:, None, :]
    m0 = torch.concatenate([p00_0, p11_0], axis=-1) @ w_si0
    m1 = torch.einsum('ejp,pc->ejc', torch.concatenate([p01_1, p10_1, p11_1], axis=-1), w_si1)
    agg0 = _segment_sum(m0, dst, N)
    agg1 = _segment_sum(m1.reshape(E, 3 * C), dst, N).reshape(N, 3, C)
    gate = _sigmoid(agg0)
    out1 = agg1 * gate[:, None, :]
    return torch.concatenate([agg0, out1.reshape(N, 3 * C)], axis=-1)
```

```asm
; @launch grid=(256,1,1) block=(768,1,1) lds=161792
    .amdgcn_target "amdgcn-amd-amdhsa--gfx950"
    .text
    .globl standalone__tensor_product_equiv_equiformer__graph_kernel
    .p2align 8
    .type standalone__tensor_product_equiv_equiformer__graph_kernel,@function
standalone__tensor_product_equiv_equiformer__graph_kernel:
    s_cmp_ge_u32 s2, 256
    s_cbranch_scc1 L_end
    s_load_dwordx8 s[16:23], s[0:1], 8
    s_load_dwordx2 s[8:9], s[0:1], 88
    s_load_dwordx2 s[4:5], s[0:1], 0
    s_load_dwordx4 s[24:27], s[0:1], 40
    s_load_dwordx2 s[28:29], s[0:1], 56
    s_load_dwordx2 s[10:11], s[0:1], 72
    v_lshrrev_b32 v4, 6, v0
    v_and_b32 v1, 63, v0
    v_min_u32 v5, 624, v0
    v_readfirstlane_b32 s14, v4
    s_mul_i32 s48, s2, 625
    v_add_u32 v5, s48, v5
    v_lshlrev_b32 v6, 4, v5
    v_lshlrev_b32 v26, 2, v0
    v_add_u32 v26, 75776, v26
    v_mov_b32 v64, 0
    ds_write_b32 v26, v64
    s_cmp_lt_u32 s14, 10
    s_cbranch_scc1 L_prod
    s_getpc_b64 s[46:47]
L_pc:
    s_lshr_b32 s48, s2, 3
    s_and_b32 s48, s48, 7
    s_mul_i32 s49, s48, 3072
    v_lshl_add_u32 v70, v1, 7, s49
    s_mov_b64 exec, 0xffffff
    s_cmp_eq_u32 s14, 11
    s_cbranch_scc1 L_wpf
    v_min_u32 v70, L_cold-L_pc, v70
    global_load_dword v71, v70, s[46:47]
    s_branch L_pfd
L_wpf:
L_pfd:
    s_mov_b64 exec, -1
    s_waitcnt lgkmcnt(0)
    s_barrier
    s_branch L_helper
L_prod:
    s_waitcnt lgkmcnt(0)
    global_load_dwordx4 v[8:11], v6, s[22:23]
    s_add_u32 s30, s8, 10485760
    s_addc_u32 s31, s9, 0
    s_load_dword s73, s[30:31], 0
    v_lshlrev_b32 v7, 3, v5
    v_mul_u32_u24 v5, 24, v5
    s_barrier
    global_load_dwordx4 v[12:15], v6, s[20:21]
    global_load_dwordx2 v[16:17], v7, s[18:19]
    global_load_dwordx4 v[20:23], v5, s[16:17]
    global_load_dwordx2 v[24:25], v5, s[16:17] offset:16
    v_mov_b32 v65, 0
    v_mov_b32 v66, 0
    v_mov_b32 v67, 0
    v_lshlrev_b32 v68, 4, v0
    ds_write_b128 v68, v[64:67] offset:1024
    ds_write_b128 v68, v[64:67] offset:13312
    ds_write_b128 v68, v[64:67] offset:25600
    ds_write_b128 v68, v[64:67] offset:37888
    ds_write_b128 v68, v[64:67] offset:50176
    ds_write_b128 v68, v[64:67] offset:62464
    v_and_b32 v2, 15, v0
    v_lshrrev_b32 v3, 4, v1
    s_and_b32 s3, s2, 7
    s_lshl_b32 s3, s3, 5
    s_lshr_b32 s12, s2, 3
    s_add_u32 s3, s3, s12
    s_mov_b32 s6, 5120000
    s_mov_b32 s7, 0x20000
    s_mul_i32 s12, s3, 625
    s_add_u32 s13, s12, 640
    s_add_u32 s12, s12, 15
    s_lshr_b32 s12, s12, 4
    s_lshr_b32 s13, s13, 4
    s_sub_u32 s13, s13, s12
    s_mov_b32 s15, 0
    s_mov_b32 s60, 0
    s_mov_b32 s61, 0
    s_lshr_b32 s75, s3, 2
    s_lshl_b32 s75, s75, 4
    s_and_b32 s58, s3, 1
    s_lshl_b32 s58, s58, 3
    s_add_u32 s75, s75, s58
    s_and_b32 s58, s3, 2
    s_lshl_b32 s58, s58, 9
    s_add_u32 s75, s75, s58
    s_and_b32 s58, s75, 63
    s_sub_u32 s75, s75, s58
    s_mul_i32 s75, s75, 2
    s_add_u32 s75, s75, s58
    s_add_u32 s75, s75, 8388608
    v_mov_b32 v7, 1
    v_lshlrev_b32 v27, 4, v1
    s_lshl_b32 s48, s14, 10
    s_add_u32 s48, s48, 3072
    v_mov_b32 v69, 625
    v_cmp_lt_u32 s[62:63], v0, v69
    v_mov_b32 v69, 75776
    s_mov_b32 s50, 0x3fc
    s_waitcnt vmcnt(4)
    v_mul_u32_u24 v28, 214749, v8
    v_mul_u32_u24 v29, 214749, v9
    v_mul_u32_u24 v30, 214749, v10
    v_mul_u32_u24 v31, 214749, v11
    s_mov_b64 exec, s[62:63]
    v_lshrrev_b32 v28, 21, v28
    v_and_or_b32 v28, v28, s50, v69
    ds_add_rtn_u32 v32, v28, v7
    v_lshrrev_b32 v29, 21, v29
    v_and_or_b32 v29, v29, s50, v69
    ds_add_rtn_u32 v33, v29, v7
    v_lshrrev_b32 v30, 21, v30
    v_and_or_b32 v30, v30, s50, v69
    ds_add_rtn_u32 v34, v30, v7
    v_lshrrev_b32 v31, 21, v31
    v_and_or_b32 v31, v31, s50, v69
    ds_add_rtn_u32 v35, v31, v7
    s_mov_b64 exec, -1
    v_add_u32 v26, v27, v69
    s_waitcnt lgkmcnt(0)
    s_barrier
    ds_read_b128 v[56:59], v26
    s_add_u32 s73, s73, 0x9e3779b1
    s_lshl_b32 s74, s73, 24
    s_mul_i32 s49, s2, 30848
    s_lshl_b32 s51, s73, 31
    s_waitcnt lgkmcnt(0)
    v_add_u32 v37, v56, v57
    v_add_u32 v38, v58, v59
    v_add_u32 v36, v37, v38
    v_mov_b32 v39, v36
    s_nop 1
    v_add_u32_dpp v39, v39, v39 row_shr:1 row_mask:0xf bank_mask:0xf
    s_nop 1
    v_add_u32_dpp v39, v39, v39 row_shr:2 row_mask:0xf bank_mask:0xf
    s_nop 1
    v_add_u32_dpp v39, v39, v39 row_shr:4 row_mask:0xf bank_mask:0xf
    s_nop 1
    v_add_u32_dpp v39, v39, v39 row_shr:8 row_mask:0xf bank_mask:0xf
    s_nop 1
    v_add_u32_dpp v39, v39, v39 row_bcast:15 row_mask:0xa bank_mask:0xf
    s_nop 1
    v_add_u32_dpp v39, v39, v39 row_bcast:31 row_mask:0xc bank_mask:0xf
    v_sub_u32 v60, v39, v36
    v_add_u32 v61, v60, v56
    v_add_u32 v62, v60, v37
    v_add_u32 v63, v62, v58
    v_add_u32 v36, s48, v26
    ds_write_b128 v36, v[60:63]
    s_mov_b64 exec, s[62:63]
    v_add_u32 v36, s48, v28
    v_add_u32 v37, s48, v29
    v_add_u32 v38, s48, v30
    v_add_u32 v39, s48, v31
    ds_read_b32 v36, v36
    ds_read_b32 v37, v37
    ds_read_b32 v38, v38
    ds_read_b32 v39, v39
    v_mov_b32 v69, 89088
    s_waitcnt lgkmcnt(0)
    v_add_u32 v32, v32, v36
    v_mad_u32_u24 v32, v32, 12, v69
    v_add_u32 v33, v33, v37
    v_mad_u32_u24 v33, v33, 12, v69
    v_add_u32 v34, v34, v38
    v_mad_u32_u24 v34, v34, 12, v69
    v_add_u32 v35, v35, v39
    v_mad_u32_u24 v35, v35, 12, v69
    s_waitcnt vmcnt(3)
    v_cmp_le_u32 vcc, 5000, v12
    v_lshl_or_b32 v48, v8, 17, v12
    v_or_b32 v48, s51, v48
    v_or_b32 v52, 0x10000, v48
    v_cndmask_b32 v48, v48, v52, vcc
    ds_write_b32 v32, v48 offset:8
    v_cmp_le_u32 vcc, 5000, v13
    v_lshl_or_b32 v49, v9, 17, v13
    v_or_b32 v49, s51, v49
    v_or_b32 v52, 0x10000, v49
    v_cndmask_b32 v49, v49, v52, vcc
    ds_write_b32 v33, v49 offset:8
    v_cmp_le_u32 vcc, 5000, v14
    v_lshl_or_b32 v50, v10, 17, v14
    v_or_b32 v50, s51, v50
    v_or_b32 v52, 0x10000, v50
    v_cndmask_b32 v50, v50, v52, vcc
    ds_write_b32 v34, v50 offset:8
    v_cmp_le_u32 vcc, 5000, v15
    v_lshl_or_b32 v51, v11, 17, v15
    v_or_b32 v51, s51, v51
    v_or_b32 v52, 0x10000, v51
    v_cndmask_b32 v51, v51, v52, vcc
    ds_write_b32 v35, v51 offset:8
    s_waitcnt vmcnt(0)
    v_lshlrev_b32 v36, 16, v16
    v_lshlrev_b32 v37, 16, v20
    v_and_b32 v38, 0xffff0000, v20
    v_lshlrev_b32 v39, 16, v21
    v_mul_f32 v37, v36, v37
    v_mul_f32 v38, v36, v38
    v_mul_f32 v39, v36, v39
    v_cvt_pk_bf16_f32 v40, v36, v37
    v_cvt_pk_bf16_f32 v41, v38, v39
    ds_write2_b32 v32, v40, v41 offset0:0 offset1:1
    v_alignbit_b32 v12, v41, v48, 31
    v_bitop3_b32 v52, v48, v41, 1 bitop3:0xbe
    v_xad_u32 v12, v12, v40, v48
    v_mul_lo_u32 v12, v12, v52
    ds_add_u32 v28, v12 offset:1024
    v_and_b32 v36, 0xffff0000, v16
    v_and_b32 v37, 0xffff0000, v21
    v_lshlrev_b32 v38, 16, v22
    v_and_b32 v39, 0xffff0000, v22
    v_mul_f32 v37, v36, v37
    v_mul_f32 v38, v36, v38
    v_mul_f32 v39, v36, v39
    v_cvt_pk_bf16_f32 v42, v36, v37
    v_cvt_pk_bf16_f32 v43, v38, v39
    ds_write2_b32 v33, v42, v43 offset0:0 offset1:1
    v_alignbit_b32 v13, v43, v49, 31
    v_bitop3_b32 v52, v49, v43, 1 bitop3:0xbe
    v_xad_u32 v13, v13, v42, v49
    v_mul_lo_u32 v13, v13, v52
    ds_add_u32 v29, v13 offset:1024
    v_lshlrev_b32 v36, 16, v17
    v_lshlrev_b32 v37, 16, v23
    v_and_b32 v38, 0xffff0000, v23
    v_lshlrev_b32 v39, 16, v24
    v_mul_f32 v37, v36, v37
    v_mul_f32 v38, v36, v38
    v_mul_f32 v39, v36, v39
    v_cvt_pk_bf16_f32 v44, v36, v37
    v_cvt_pk_bf16_f32 v45, v38, v39
    ds_write2_b32 v34, v44, v45 offset0:0 offset1:1
    v_alignbit_b32 v14, v45, v50, 31
    v_bitop3_b32 v52, v50, v45, 1 bitop3:0xbe
    v_xad_u32 v14, v14, v44, v50
    v_mul_lo_u32 v14, v14, v52
    ds_add_u32 v30, v14 offset:1024
    v_and_b32 v36, 0xffff0000, v17
    v_and_b32 v37, 0xffff0000, v24
    v_lshlrev_b32 v38, 16, v25
    v_and_b32 v39, 0xffff0000, v25
    v_mul_f32 v37, v36, v37
    v_mul_f32 v38, v36, v38
    v_mul_f32 v39, v36, v39
    v_cvt_pk_bf16_f32 v46, v36, v37
    v_cvt_pk_bf16_f32 v47, v38, v39
    ds_write2_b32 v35, v46, v47 offset0:0 offset1:1
    v_alignbit_b32 v15, v47, v51, 31
    v_bitop3_b32 v52, v51, v47, 1 bitop3:0xbe
    v_xad_u32 v15, v15, v46, v51
    v_mul_lo_u32 v15, v15, v52
    ds_add_u32 v31, v15 offset:1024
    s_mov_b64 exec, -1
    v_add_u32 v5, 89088, v68
    v_add_u32 v4, s49, v68
    v_add_u32 v6, 10240, v4
    v_add_u32 v7, 20480, v4
    s_cmp_lt_u32 s14, 2
    s_cbranch_scc1 L_pub
    s_waitcnt lgkmcnt(0)
    s_barrier
    ds_read_b128 v[32:35], v5
    ds_read_b128 v[8:11], v5 offset:10240
    ds_read_b128 v[12:15], v5 offset:20480
L_pubd:
    s_waitcnt lgkmcnt(2)
    global_store_dwordx4 v4, v[32:35], s[8:9] sc1
    s_waitcnt lgkmcnt(1)
    global_store_dwordx4 v6, v[8:11], s[8:9] sc1
    v_cmp_gt_u32 vcc, 600, v0
    s_and_b64 exec, exec, vcc
    s_waitcnt lgkmcnt(0)
    global_store_dwordx4 v7, v[12:15], s[8:9] sc1
    s_mov_b64 exec, -1
    s_cmp_ge_u32 s14, 8
    s_cbranch_scc1 L_p89
    v_and_b32 v28, 7, v2
    v_lshl_add_u32 v28, v28, 2, v3
    v_lshl_add_u32 v28, v28, 3, s14
    v_lshrrev_b32 v29, 6, v28
    v_lshlrev_b32 v29, 5, v29
    v_and_or_b32 v29, v28, 31, v29
    v_mul_u32_u24 v29, 4224, v29
    v_bfe_u32 v30, v28, 5, 1
    v_lshl_add_u32 v30, v30, 6, v29
    v_add_u32 v30, s75, v30
    v_lshlrev_b32 v69, 7, v28
    v_add_u32 v69, 9961472, v69
    v_mul_u32_u24 v64, 30848, v28
    v_lshrrev_b32 v65, 3, v2
    v_add_u32 v65, 16, v65
    v_mad_u32_u24 v64, v65, 12, v64
    v_lshl_add_u32 v28, v3, 3, s14
    v_mul_u32_u24 v28, 30848, v28
    v_mul_u32_u24 v29, 12, v2
    v_add_u32 v31, v28, v29
    s_mov_b32 s68, s8
    s_mov_b32 s69, s9
    s_mov_b32 s70, 8388608
    s_mov_b32 s71, 0x20000
    v_add_u32 v26, 16, v2
    s_lshl_b32 s48, s2, 3
    s_add_u32 s48, s48, s14
    s_mul_i32 s48, s48, 5
    v_add_u32 v27, s48, v1
    v_cmp_gt_u32 vcc, 10000, v27
    v_mov_b32 v28, 4292407552
    v_mov_b32 v29, 2560000
    v_cndmask_b32 v28, v28, v29, vcc
    s_and_b32 s48, s2, 7
    s_mul_i32 s48, s48, 5
    s_sub_u32 s48, s48, 16
    v_add_u32 v29, s48, v1
    v_subrev_u32 v36, 40, v29
    v_min_u32 v29, v29, v36
    s_and_b32 s48, s2, 0xf8
    s_add_u32 s48, s48, s14
    s_mul_i32 s48, s48, 40
    v_add_u32 v29, s48, v29
    v_cmp_gt_u32 vcc, 16, v1
    s_nop 1
    v_cndmask_b32 v27, v29, v27, vcc
    v_cndmask_b32 v28, 0, v28, vcc
    v_lshrrev_b32 v29, 1, v27
    v_lshl_add_u32 v28, v29, 9, v28
    v_and_b32 v27, 1, v27
    v_lshl_add_u32 v27, v27, 7, v28
    s_mov_b32 s48, 4294901791
    s_mov_b32 s49, 0
    v_mov_b32 v29, 0x40000000
    v_cndmask_b32 v27, v29, v27, s[48:49]
    v_and_b32 v20, 3, v2
    v_mul_u32_u24 v20, 0x5555, v20
    v_lshl_add_u32 v21, v3, 5, v2
    v_mov_b32 v22, 1
    v_mov_b32 v23, 4
    v_lshlrev_b32 v16, 4, v2
    v_mov_b32 v17, 512
    v_lshlrev_b32 v18, 2, v3
    v_lshl_add_u32 v18, v2, 4, v18
    v_lshrrev_b32 v19, 1, v3
    v_lshlrev_b32 v19, 5, v19
    v_and_b32 v24, 1, v3
    v_lshl_add_u32 v19, v24, 4, v19
    v_lshrrev_b32 v24, 2, v2
    v_lshl_add_u32 v19, v24, 1, v19
    v_add_u32 v19, 23552, v19
    s_lshl_b32 s50, s12, 3
    s_sub_u32 s50, 0, s50
    s_lshr_b32 s48, s51, 14
    s_sub_u32 s50, s50, s48
    v_mov_b32 v24, 0x40000000
    v_mov_b32 v25, 25344
    s_mov_b32 s59, 1024
    s_mov_b32 s72, 0
    s_mov_b32 s66, 0
    s_mov_b32 s57, 0
    s_mov_b64 s[52:53], 0
    v_mov_b32 v7, s73
    s_waitcnt vmcnt(0)
    s_barrier
    s_mov_b32 exec_lo, 0x00ff00ff
    s_mov_b32 exec_hi, 0x00ff00ff
    global_load_dwordx2 v[6:7], v30, s[8:9] sc1
    s_mov_b64 exec, -1
    v_mov_b32 v72, 0
    v_mov_b32 v73, 0
    v_mov_b32 v74, 0
    v_mov_b32 v75, 0
    v_mov_b32 v76, 0
    v_mov_b32 v77, 0
    v_mov_b32 v78, 0
    v_mov_b32 v79, 0
    v_mov_b32 v80, 0
    v_mov_b32 v81, 0
    v_mov_b32 v82, 0
    v_mov_b32 v83, 0
    v_mov_b32 v84, 0
    v_mov_b32 v85, 0
    v_mov_b32 v86, 0
    v_mov_b32 v87, 0
    v_mov_b32 v88, 0
    v_mov_b32 v89, 0
    v_mov_b32 v90, 0
    v_mov_b32 v91, 0
    v_mov_b32 v92, 0
    v_mov_b32 v93, 0
    v_mov_b32 v94, 0
    v_mov_b32 v95, 0
    v_mov_b32 v96, 0
    v_mov_b32 v97, 0
    v_mov_b32 v98, 0
    v_mov_b32 v99, 0
    v_mov_b32 v100, 0
    v_mov_b32 v101, 0
    v_mov_b32 v102, 0
    v_mov_b32 v103, 0
    v_mov_b32 v104, 0
    v_mov_b32 v105, 0
    v_mov_b32 v106, 0
    v_mov_b32 v107, 0
    v_mov_b32 v108, 0
    v_mov_b32 v109, 0
    v_mov_b32 v110, 0
    v_mov_b32 v111, 0
    v_mov_b32 v112, 0
    v_mov_b32 v113, 0
    v_mov_b32 v114, 0
    v_mov_b32 v115, 0
    v_mov_b32 v116, 0
    v_mov_b32 v117, 0
    v_mov_b32 v118, 0
    v_mov_b32 v119, 0
    v_mov_b32 v120, 0
    v_mov_b32 v121, 0
    v_mov_b32 v122, 0
    v_mov_b32 v123, 0
    v_mov_b32 v124, 0
    v_mov_b32 v125, 0
    v_mov_b32 v126, 0
    v_mov_b32 v127, 0
    v_mov_b32 v128, 0
    v_mov_b32 v129, 0
    v_mov_b32 v130, 0
    v_mov_b32 v131, 0
    v_mov_b32 v132, 0
    v_mov_b32 v133, 0
    v_mov_b32 v134, 0
    v_mov_b32 v135, 0
    v_mov_b32 v136, 0
    v_mov_b32 v137, 0
    v_mov_b32 v138, 0
    v_mov_b32 v139, 0
    v_mov_b32 v140, 0
    v_mov_b32 v141, 0
    v_mov_b32 v142, 0
    v_mov_b32 v143, 0
    v_mov_b32 v144, 0
    v_mov_b32 v145, 0
    v_mov_b32 v146, 0
    v_mov_b32 v147, 0
    v_mov_b32 v148, 0
    v_mov_b32 v149, 0
    v_mov_b32 v150, 0
    v_mov_b32 v151, 0
    v_mov_b32 v152, 0
    v_mov_b32 v153, 0
    v_mov_b32 v154, 0
    v_mov_b32 v155, 0
    v_mov_b32 v156, 0
    v_mov_b32 v157, 0
    v_mov_b32 v158, 0
    v_mov_b32 v159, 0
    v_mov_b32 v160, 0
    v_mov_b32 v161, 0
    v_mov_b32 v162, 0
    v_mov_b32 v163, 0
    v_mov_b32 v164, 0
    v_mov_b32 v165, 0
    v_mov_b32 v166, 0
    v_mov_b32 v167, 0
    s_mov_b32 exec_lo, 0x00ff00ff
    s_mov_b32 exec_hi, 0x00ff00ff
L_tpoll:
    s_waitcnt vmcnt(0)
    v_and_b32 v4, 0xff000000, v6
    v_cmp_ne_u32 vcc, s74, v4
    s_cmp_eq_u64 vcc, 0
    s_cbranch_scc1 L_tready
    s_sleep 1
    s_mov_b64 exec, vcc
    global_load_dwordx2 v[6:7], v30, s[8:9] sc1
    s_add_u32 s72, s72, 1
    s_cmp_lt_u32 s72, 0x80000
    s_cbranch_scc1 L_tpoll
    s_endpgm
L_tready:
    s_mov_b64 exec, -1
    v_mov_b32_dpp v6, v6 row_shr:8 row_mask:0xf bank_mask:0xc
    v_and_b32 v5, 0xfff, v6
    v_bfe_u32 v4, v6, 12, 12
    v_mul_u32_u24 v5, 12, v5
    v_sub_u32 v14, v4, v65
    v_add_u32 v68, v5, v64
    v_mov_b32 v29, v31
    s_mov_b32 s51, 0
    v_cmp_lt_u32 vcc, 32, v4
    s_cmp_lg_u64 vcc, 0
    s_cbranch_scc1 L_long
L_load:
    v_cmp_lt_i32 s[32:33], 0, v14
    s_and_b64 exec, exec, s[32:33]
    s_cbranch_scc0 L_x1
    global_load_dwordx3 v[72:74], v68, s[8:9] offset:0 sc1
    s_mov_b32 s51, 1
    v_cmp_lt_i32 s[34:35], 2, v14
    s_and_b64 exec, exec, s[34:35]
    s_cbranch_scc0 L_x1
    global_load_dwordx3 v[76:78], v68, s[8:9] offset:24 sc1
    s_mov_b32 s51, 2
    v_cmp_lt_i32 s[36:37], 4, v14
    s_and_b64 exec, exec, s[36:37]
    s_cbranch_scc0 L_x1
    global_load_dwordx3 v[80:82], v68, s[8:9] offset:48 sc1
    s_mov_b32 s51, 3
    v_cmp_lt_i32 s[38:39], 6, v14
    s_and_b64 exec, exec, s[38:39]
    s_cbranch_scc0 L_x1
    global_load_dwordx3 v[84:86], v68, s[8:9] offset:72 sc1
    s_mov_b32 s51, 4
    v_cmp_lt_i32 s[40:41], 8, v14
    s_and_b64 exec, exec, s[40:41]
    s_cbranch_scc0 L_x1
    global_load_dwordx3 v[88:90], v68, s[8:9] offset:96 sc1
    s_mov_b32 s51, 5
    v_cmp_lt_i32 s[42:43], 10, v14
    s_and_b64 exec, exec, s[42:43]
    s_cbranch_scc0 L_x1
    global_load_dwordx3 v[92:94], v68, s[8:9] offset:120 sc1
    s_mov_b32 s51, 6
    v_cmp_lt_i32 s[44:45], 12, v14
    s_and_b64 exec, exec, s[44:45]
    s_cbranch_scc0 L_x1
    global_load_dwordx3 v[96:98], v68, s[8:9] offset:144 sc1
    s_mov_b32 s51, 7
    v_cmp_lt_i32 s[46:47], 14, v14
    s_and_b64 exec, exec, s[46:47]
    s_cbranch_scc0 L_x1
    global_load_dwordx3 v[100:102], v68, s[8:9] offset:168 sc1
    s_mov_b32 s51, 8
L_x1:
    s_mov_b64 exec, -1
    v_mov_b32_dpp v9, v4 row_newbcast:0 row_mask:0xf bank_mask:0xf
    v_cmp_lt_u32 s[16:17], v2, v9
    v_add_u32_dpp v10, v5, v29 row_newbcast:0 row_mask:0xf bank_mask:0xf
    v_add_u32 v29, 987136, v29
    v_cndmask_b32 v10, v24, v10, s[16:17]
    buffer_load_dwordx3 v[32:34], v10, s[68:71], 0 offen sc1
    v_mov_b32_dpp v9, v4 row_newbcast:1 row_mask:0xf bank_mask:0xf
    v_cmp_lt_u32 s[18:19], v2, v9
    v_add_u32_dpp v11, v5, v29 row_newbcast:1 row_mask:0xf bank_mask:0xf
    v_add_u32 v29, 987136, v29
    v_cndmask_b32 v11, v24, v11, s[18:19]
    buffer_load_dwordx3 v[36:38], v11, s[68:71], 0 offen sc1
    v_mov_b32_dpp v9, v4 row_newbcast:2 row_mask:0xf bank_mask:0xf
    v_cmp_lt_u32 s[20:21], v2, v9
    v_add_u32_dpp v10, v5, v29 row_newbcast:2 row_mask:0xf bank_mask:0xf
    v_add_u32 v29, 987136, v29
    v_cndmask_b32 v10, v24, v10, s[20:21]
    buffer_load_dwordx3 v[40:42], v10, s[68:71], 0 offen sc1
    v_mov_b32_dpp v9, v4 row_newbcast:3 row_mask:0xf bank_mask:0xf
    v_cmp_lt_u32 s[22:23], v2, v9
    v_add_u32_dpp v11, v5, v29 row_newbcast:3 row_mask:0xf bank_mask:0xf
    v_add_u32 v29, 987136, v29
    v_cndmask_b32 v11, v24, v11, s[22:23]
    buffer_load_dwordx3 v[44:46], v11, s[68:71], 0 offen sc1
    v_mov_b32_dpp v9, v4 row_newbcast:4 row_mask:0xf bank_mask:0xf
    v_cmp_lt_u32 s[24:25], v2, v9
    v_add_u32_dpp v10, v5, v29 row_newbcast:4 row_mask:0xf bank_mask:0xf
    v_add_u32 v29, 987136, v29
    v_cndmask_b32 v10, v24, v10, s[24:25]
    buffer_load_dwordx3 v[48:50], v10, s[68:71], 0 offen sc1
    v_mov_b32_dpp v9, v4 row_newbcast:5 row_mask:0xf bank_mask:0xf
    v_cmp_lt_u32 s[26:27], v2, v9
    v_add_u32_dpp v11, v5, v29 row_newbcast:5 row_mask:0xf bank_mask:0xf
    v_add_u32 v29, 987136, v29
    v_cndmask_b32 v11, v24, v11, s[26:27]
    buffer_load_dwordx3 v[52:54], v11, s[68:71], 0 offen sc1
    v_mov_b32_dpp v9, v4 row_newbcast:6 row_mask:0xf bank_mask:0xf
    v_cmp_lt_u32 s[28:29], v2, v9
    v_add_u32_dpp v10, v5, v29 row_newbcast:6 row_mask:0xf bank_mask:0xf
    v_add_u32 v29, 987136, v29
    v_cndmask_b32 v10, v24, v10, s[28:29]
    buffer_load_dwordx3 v[56:58], v10, s[68:71], 0 offen sc1
    v_mov_b32_dpp v9, v4 row_newbcast:7 row_mask:0xf bank_mask:0xf
    v_cmp_lt_u32 s[30:31], v2, v9
    v_add_u32_dpp v11, v5, v29 row_newbcast:7 row_mask:0xf bank_mask:0xf
    v_add_u32 v29, 987136, v29
    v_cndmask_b32 v11, v24, v11, s[30:31]
    buffer_load_dwordx3 v[60:62], v11, s[68:71], 0 offen sc1
    s_waitcnt vmcnt(8)
    v_subrev_u32 v7, s73, v7
    s_cmp_le_u32 s51, 0
    s_cbranch_scc1 L_x4
    s_mov_b64 exec, s[32:33]
    v_alignbit_b32 v6, v73, v74, 31
    v_bitop3_b32 v9, v74, v73, 1 bitop3:0xbe
    v_xad_u32 v6, v6, v72, v74
    v_mul_lo_u32 v6, v6, v9
    v_sub_u32 v7, v7, v6
    s_cmp_le_u32 s51, 1
    s_cbranch_scc1 L_x4
    s_mov_b64 exec, s[34:35]
    v_alignbit_b32 v6, v77, v78, 31
    v_bitop3_b32 v9, v78, v77, 1 bitop3:0xbe
    v_xad_u32 v6, v6, v76, v78
    v_mul_lo_u32 v6, v6, v9
    v_sub_u32 v7, v7, v6
    s_cmp_le_u32 s51, 2
    s_cbranch_scc1 L_x4
    s_mov_b64 exec, s[36:37]
    v_alignbit_b32 v6, v81, v82, 31
    v_bitop3_b32 v9, v82, v81, 1 bitop3:0xbe
    v_xad_u32 v6, v6, v80, v82
    v_mul_lo_u32 v6, v6, v9
    v_sub_u32 v7, v7, v6
    s_cmp_le_u32 s51, 3
    s_cbranch_scc1 L_x4
    s_mov_b64 exec, s[38:39]
    v_alignbit_b32 v6, v85, v86, 31
    v_bitop3_b32 v9, v86, v85, 1 bitop3:0xbe
    v_xad_u32 v6, v6, v84, v86
    v_mul_lo_u32 v6, v6, v9
    v_sub_u32 v7, v7, v6
    s_cmp_le_u32 s51, 4
    s_cbranch_scc1 L_x4
    s_mov_b64 exec, s[40:41]
    v_alignbit_b32 v6, v89, v90, 31
    v_bitop3_b32 v9, v90, v89, 1 bitop3:0xbe
    v_xad_u32 v6, v6, v88, v90
    v_mul_lo_u32 v6, v6, v9
    v_sub_u32 v7, v7, v6
    s_cmp_le_u32 s51, 5
    s_cbranch_scc1 L_x4
    s_mov_b64 exec, s[42:43]
    v_alignbit_b32 v6, v93, v94, 31
    v_bitop3_b32 v9, v94, v93, 1 bitop3:0xbe
    v_xad_u32 v6, v6, v92, v94
    v_mul_lo_u32 v6, v6, v9
    v_sub_u32 v7, v7, v6
    s_cmp_le_u32 s51, 6
    s_cbranch_scc1 L_x4
    s_mov_b64 exec, s[44:45]
    v_alignbit_b32 v6, v97, v98, 31
    v_bitop3_b32 v9, v98, v97, 1 bitop3:0xbe
    v_xad_u32 v6, v6, v96, v98
    v_mul_lo_u32 v6, v6, v9
    v_sub_u32 v7, v7, v6
    s_cmp_le_u32 s51, 7
    s_cbranch_scc1 L_x4
    s_mov_b64 exec, s[46:47]
    v_alignbit_b32 v6, v101, v102, 31
    v_bitop3_b32 v9, v102, v101, 1 bitop3:0xbe
    v_xad_u32 v6, v6, v100, v102
    v_mul_lo_u32 v6, v6, v9
    v_sub_u32 v7, v7, v6
L_x4:
    s_mov_b64 exec, -1
    v_mov_b32 v71, 0
    s_mov_b32 exec_lo, 0x0f0f0f0f
    s_mov_b32 exec_hi, 0x0f0f0f0f
    v_swap_b32 v71, v7
    s_mov_b64 exec, -1
    s_andn2_b64 s[16:17], s[16:17], s[52:53]
    s_andn2_b64 s[18:19], s[18:19], s[52:53]
    s_andn2_b64 s[20:21], s[20:21], s[52:53]
    s_andn2_b64 s[22:23], s[22:23], s[52:53]
    s_waitcnt vmcnt(7)
    v_alignbit_b32 v6, v33, v34, 31
    v_bitop3_b32 v9, v34, v33, 1 bitop3:0xbe
    v_xad_u32 v6, v6, v32, v34
    v_mul_lo_u32 v6, v6, v9
    v_sub_u32 v71, v71, v6
    v_bfe_u32 v12, v34, 16, 1
    v_mad_u32_u16 v35, v34, v23, s50 op_sel:[1,0,0,0]
    v_lshl_add_u32 v12, v12, 3, -4
    s_waitcnt vmcnt(6)
    v_alignbit_b32 v6, v37, v38, 31
    v_bitop3_b32 v9, v38, v37, 1 bitop3:0xbe
    v_xad_u32 v6, v6, v36, v38
    v_mul_lo_u32 v6, v6, v9
    v_sub_u32 v71, v71, v6
    v_bfe_u32 v13, v38, 16, 1
    v_mad_u32_u16 v39, v38, v23, s50 op_sel:[1,0,0,0]
    v_lshl_add_u32 v13, v13, 3, -4
    s_waitcnt vmcnt(5)
    v_alignbit_b32 v6, v41, v42, 31
    v_bitop3_b32 v9, v42, v41, 1 bitop3:0xbe
    v_xad_u32 v6, v6, v40, v42
    v_mul_lo_u32 v6, v6, v9
    v_sub_u32 v71, v71, v6
    v_bfe_u32 v22, v42, 16, 1
    v_mad_u32_u16 v43, v42, v23, s50 op_sel:[1,0,0,0]
    v_lshl_add_u32 v22, v22, 3, -4
    s_waitcnt vmcnt(4)
    v_alignbit_b32 v6, v45, v46, 31
    v_bitop3_b32 v9, v46, v45, 1 bitop3:0xbe
    v_xad_u32 v6, v6, v44, v46
    v_mul_lo_u32 v6, v6, v9
    v_sub_u32 v71, v71, v6
    v_bfe_u32 v26, v46, 16, 1
    v_mad_u32_u16 v47, v46, v23, s50 op_sel:[1,0,0,0]
    v_lshl_add_u32 v26, v26, 3, -4
    v_add_u32_dpp v71, v71, v71 row_shr:1 row_mask:0xf bank_mask:0xf
    s_nop 1
    v_add_u32_dpp v71, v71, v71 row_shr:2 row_mask:0xf bank_mask:0xf
    s_nop 1
    v_add_u32_dpp v71, v71, v71 row_shr:4 row_mask:0xf bank_mask:0xf
    s_nop 1
    v_add_u32_dpp v71, v71, v71 row_shr:8 row_mask:0xf bank_mask:0xf
    s_nop 1
    v_add_u32_dpp v71, v71, v71 row_bcast:15 row_mask:0xa bank_mask:0xf
    s_nop 1
    v_add_u32_dpp v71, v71, v71 row_bcast:31 row_mask:0xc bank_mask:0xf
    s_nop 0
    v_readlane_b32 s48, v71, 63
    s_andn2_b32 s48, s48, s66
    s_cbranch_scc1 L_retry
    s_mov_b64 exec, s[16:17]
    ds_add_rtn_u32 v35, v35, v12
    s_mov_b64 exec, s[18:19]
    ds_add_rtn_u32 v39, v39, v13
    s_mov_b64 exec, s[20:21]
    ds_add_rtn_u32 v43, v43, v22
    s_mov_b64 exec, s[22:23]
    ds_add_rtn_u32 v47, v47, v26
    s_mov_b64 exec, -1
    s_waitcnt vmcnt(3)
    v_alignbit_b32 v6, v49, v50, 31
    v_bitop3_b32 v9, v50, v49, 1 bitop3:0xbe
    v_xad_u32 v6, v6, v48, v50
    v_mul_lo_u32 v6, v6, v9
    v_sub_u32 v7, v7, v6
    v_bfe_u32 v28, v50, 16, 1
    v_mad_u32_u16 v51, v50, v23, s50 op_sel:[1,0,0,0]
    v_lshl_add_u32 v28, v28, 3, -4
    s_waitcnt lgkmcnt(0)
    s_mov_b64 exec, s[16:17]
    v_med3_u32 v35, v35, s59, v25
    v_lshlrev_b32 v8, 1, v35
    ds_write_b32 v35, v34
    ds_write_b64 v8, v[32:33] offset:23552
    s_mov_b64 exec, s[18:19]
    v_med3_u32 v39, v39, s59, v25
    v_lshlrev_b32 v8, 1, v39
    ds_write_b32 v39, v38
    ds_write_b64 v8, v[36:37] offset:23552
    s_mov_b64 exec, s[20:21]
    v_med3_u32 v43, v43, s59, v25
    v_lshlrev_b32 v8, 1, v43
    ds_write_b32 v43, v42
    ds_write_b64 v8, v[40:41] offset:23552
    s_mov_b64 exec, s[22:23]
    v_med3_u32 v47, v47, s59, v25
    v_lshlrev_b32 v8, 1, v47
    ds_write_b32 v47, v46
    ds_write_b64 v8, v[44:45] offset:23552
    s_mov_b64 exec, -1
    s_mov_b64 s[52:53], -1
    s_waitcnt vmcnt(2)
    v_alignbit_b32 v6, v53, v54, 31
    v_bitop3_b32 v9, v54, v53, 1 bitop3:0xbe
    v_xad_u32 v6, v6, v52, v54
    v_mul_lo_u32 v6, v6, v9
    v_sub_u32 v7, v7, v6
    v_bfe_u32 v66, v54, 16, 1
    v_mad_u32_u16 v55, v54, v23, s50 op_sel:[1,0,0,0]
    v_lshl_add_u32 v66, v66, 3, -4
    s_waitcnt vmcnt(1)
    v_alignbit_b32 v6, v57, v58, 31
    v_bitop3_b32 v9, v58, v57, 1 bitop3:0xbe
    v_xad_u32 v6, v6, v56, v58
    v_mul_lo_u32 v6, v6, v9
    v_sub_u32 v7, v7, v6
    v_bfe_u32 v67, v58, 16, 1
    v_mad_u32_u16 v59, v58, v23, s50 op_sel:[1,0,0,0]
    v_lshl_add_u32 v67, v67, 3, -4
    s_waitcnt vmcnt(0)
    buffer_load_dword v167, v27, s[4:7], 0 offen
    v_alignbit_b32 v6, v61, v62, 31
    v_bitop3_b32 v9, v62, v61, 1 bitop3:0xbe
    v_xad_u32 v6, v6, v60, v62
    v_mul_lo_u32 v6, v6, v9
    v_sub_u32 v7, v7, v6
    v_bfe_u32 v70, v62, 16, 1
    v_mad_u32_u16 v63, v62, v23, s50 op_sel:[1,0,0,0]
    v_lshl_add_u32 v70, v70, 3, -4
    v_add_u32_dpp v7, v7, v7 row_shr:1 row_mask:0xf bank_mask:0xf
    s_nop 1
    v_add_u32_dpp v7, v7, v7 row_shr:2 row_mask:0xf bank_mask:0xf
    s_nop 1
    v_add_u32_dpp v7, v7, v7 row_shr:4 row_mask:0xf bank_mask:0xf
    s_nop 1
    v_add_u32_dpp v7, v7, v7 row_shr:8 row_mask:0xf bank_mask:0xf
    s_nop 1
    v_add_u32_dpp v7, v7, v7 row_bcast:15 row_mask:0xa bank_mask:0xf
    s_nop 1
    v_add_u32_dpp v7, v7, v7 row_bcast:31 row_mask:0xc bank_mask:0xf
    s_nop 0
    v_readlane_b32 s48, v7, 63
    s_andn2_b32 s48, s48, s66
    s_cbranch_scc1 L_retry
    s_mov_b64 exec, s[24:25]
    ds_add_rtn_u32 v51, v51, v28
    s_mov_b64 exec, s[26:27]
    ds_add_rtn_u32 v55, v55, v66
    s_mov_b64 exec, s[28:29]
    ds_add_rtn_u32 v59, v59, v67
    s_mov_b64 exec, s[30:31]
    ds_add_rtn_u32 v63, v63, v70
    s_cmp_le_u32 s51, 0
    s_cbranch_scc1 L_x2
    s_mov_b64 exec, s[32:33]
    v_bfe_u32 v15, v74, 16, 1
    v_mad_u32_u16 v75, v74, v23, s50 op_sel:[1,0,0,0]
    v_lshl_add_u32 v15, v15, 3, -4
    ds_add_rtn_u32 v75, v75, v15
    s_cmp_le_u32 s51, 1
    s_cbranch_scc1 L_x2
    s_mov_b64 exec, s[34:35]
    v_bfe_u32 v15, v78, 16, 1
    v_mad_u32_u16 v79, v78, v23, s50 op_sel:[1,0,0,0]
    v_lshl_add_u32 v15, v15, 3, -4
    ds_add_rtn_u32 v79, v79, v15
    s_cmp_le_u32 s51, 2
    s_cbranch_scc1 L_x2
    s_mov_b64 exec, s[36:37]
    v_bfe_u32 v15, v82, 16, 1
    v_mad_u32_u16 v83, v82, v23, s50 op_sel:[1,0,0,0]
    v_lshl_add_u32 v15, v15, 3, -4
    ds_add_rtn_u32 v83, v83, v15
    s_cmp_le_u32 s51, 3
    s_cbranch_scc1 L_x2
    s_mov_b64 exec, s[38:39]
    v_bfe_u32 v15, v86, 16, 1
    v_mad_u32_u16 v87, v86, v23, s50 op_sel:[1,0,0,0]
    v_lshl_add_u32 v15, v15, 3, -4
    ds_add_rtn_u32 v87, v87, v15
    s_cmp_le_u32 s51, 4
    s_cbranch_scc1 L_x2
    s_mov_b64 exec, s[40:41]
    v_bfe_u32 v15, v90, 16, 1
    v_mad_u32_u16 v91, v90, v23, s50 op_sel:[1,0,0,0]
    v_lshl_add_u32 v15, v15, 3, -4
    ds_add_rtn_u32 v91, v91, v15
    s_cmp_le_u32 s51, 5
    s_cbranch_scc1 L_x2
    s_mov_b64 exec, s[42:43]
    v_bfe_u32 v15, v94, 16, 1
    v_mad_u32_u16 v95, v94, v23, s50 op_sel:[1,0,0,0]
    v_lshl_add_u32 v15, v15, 3, -4
    ds_add_rtn_u32 v95, v95, v15
    s_cmp_le_u32 s51, 6
    s_cbranch_scc1 L_x2
    s_mov_b64 exec, s[44:45]
    v_bfe_u32 v15, v98, 16, 1
    v_mad_u32_u16 v99, v98, v23, s50 op_sel:[1,0,0,0]
    v_lshl_add_u32 v15, v15, 3, -4
    ds_add_rtn_u32 v99, v99, v15
    s_cmp_le_u32 s51, 7
    s_cbranch_scc1 L_x2
    s_mov_b64 exec, s[46:47]
    v_bfe_u32 v15, v102, 16, 1
    v_mad_u32_u16 v103, v102, v23, s50 op_sel:[1,0,0,0]
    v_lshl_add_u32 v15, v15, 3, -4
    ds_add_rtn_u32 v103, v103, v15
L_x2:
    s_waitcnt lgkmcnt(0)
    s_mov_b64 exec, s[24:25]
    v_med3_u32 v51, v51, s59, v25
    v_lshlrev_b32 v8, 1, v51
    ds_write_b32 v51, v50
    ds_write_b64 v8, v[48:49] offset:23552
    s_mov_b64 exec, s[26:27]
    v_med3_u32 v55, v55, s59, v25
    v_lshlrev_b32 v8, 1, v55
    ds_write_b32 v55, v54
    ds_write_b64 v8, v[52:53] offset:23552
    s_mov_b64 exec, s[28:29]
    v_med3_u32 v59, v59, s59, v25
    v_lshlrev_b32 v8, 1, v59
    ds_write_b32 v59, v58
    ds_write_b64 v8, v[56:57] offset:23552
    s_mov_b64 exec, s[30:31]
    v_med3_u32 v63, v63, s59, v25
    v_lshlrev_b32 v8, 1, v63
    ds_write_b32 v63, v62
    ds_write_b64 v8, v[60:61] offset:23552
    s_cmp_le_u32 s51, 0
    s_cbranch_scc1 L_x3
    s_mov_b64 exec, s[32:33]
    v_med3_u32 v75, v75, s59, v25
    v_lshlrev_b32 v8, 1, v75
    ds_write_b32 v75, v74
    ds_write_b64 v8, v[72:73] offset:23552
    s_cmp_le_u32 s51, 1
    s_cbranch_scc1 L_x3
    s_mov_b64 exec, s[34:35]
    v_med3_u32 v79, v79, s59, v25
    v_lshlrev_b32 v8, 1, v79
    ds_write_b32 v79, v78
    ds_write_b64 v8, v[76:77] offset:23552
    s_cmp_le_u32 s51, 2
    s_cbranch_scc1 L_x3
    s_mov_b64 exec, s[36:37]
    v_med3_u32 v83, v83, s59, v25
    v_lshlrev_b32 v8, 1, v83
    ds_write_b32 v83, v82
    ds_write_b64 v8, v[80:81] offset:23552
    s_cmp_le_u32 s51, 3
    s_cbranch_scc1 L_x3
    s_mov_b64 exec, s[38:39]
    v_med3_u32 v87, v87, s59, v25
    v_lshlrev_b32 v8, 1, v87
    ds_write_b32 v87, v86
    ds_write_b64 v8, v[84:85] offset:23552
    s_cmp_le_u32 s51, 4
    s_cbranch_scc1 L_x3
    s_mov_b64 exec, s[40:41]
    v_med3_u32 v91, v91, s59, v25
    v_lshlrev_b32 v8, 1, v91
    ds_write_b32 v91, v90
    ds_write_b64 v8, v[88:89] offset:23552
    s_cmp_le_u32 s51, 5
    s_cbranch_scc1 L_x3
    s_mov_b64 exec, s[42:43]
    v_med3_u32 v95, v95, s59, v25
    v_lshlrev_b32 v8, 1, v95
    ds_write_b32 v95, v94
    ds_write_b64 v8, v[92:93] offset:23552
    s_cmp_le_u32 s51, 6
    s_cbranch_scc1 L_x3
    s_mov_b64 exec, s[44:45]
    v_med3_u32 v99, v99, s59, v25
    v_lshlrev_b32 v8, 1, v99
    ds_write_b32 v99, v98
    ds_write_b64 v8, v[96:97] offset:23552
    s_cmp_le_u32 s51, 7
    s_cbranch_scc1 L_x3
    s_mov_b64 exec, s[46:47]
    v_med3_u32 v103, v103, s59, v25
    v_lshlrev_b32 v8, 1, v103
    ds_write_b32 v103, v102
    ds_write_b64 v8, v[100:101] offset:23552
L_x3:
L_placed:
    s_mov_b64 exec, -1
    v_lshlrev_b32 v8, 3, v1
    v_mul_u32_u24 v9, 608, v1
    v_add_u32 v9, 1296, v9
    s_waitcnt lgkmcnt(0)
    s_barrier
    ds_read_b64 v[10:11], v8 offset:0
    s_waitcnt lgkmcnt(0)
    v_readlane_b32 s65, v10, 46
    v_add_u32 v10, 4, v10
    v_sub_u32 v15, v11, v10
    s_mov_b32 s57, s14
    s_add_u32 s58, s14, 8
    v_readlane_b32 s79, v10, s57
    v_readlane_b32 s52, v15, s57
    s_nop 0
    v_add_u32 v12, s79, v18
    ds_read2st64_b32 v[2:3], v12 offset0:0 offset1:1
    v_readlane_b32 s80, v10, s58
    v_readlane_b32 s53, v15, s58
    s_nop 0
    v_add_u32 v13, s80, v18
    ds_read2st64_b32 v[4:5], v13 offset0:0 offset1:1
    s_cmp_lg_u32 s15, 0
    s_cbranch_scc1 L_g_ok
    v_sub_u32 v11, v11, v9
    v_sub_u32 v9, v9, v10
    v_max_u32 v9, v9, v11
    v_cmp_lt_u32 vcc, 272, v9
    v_mov_b32 v9, 512
    v_cmp_lt_u32 s[48:49], v9, v15
    s_or_b64 vcc, vcc, s[48:49]
    s_and_b32 vcc_hi, vcc_hi, 0xff
    s_or_b32 s48, vcc_lo, vcc_hi
    s_or_b32 s48, s48, s65
    s_cmp_eq_u32 s48, 0
    s_cbranch_scc1 L_g_ok
    s_mov_b32 s15, 1
    s_max_u32 s64, s65, 32
    s_min_u32 s64, s64, 2560
    s_waitcnt vmcnt(0) lgkmcnt(0)
    s_barrier
    s_branch L_slow_load
L_g_ok:
    s_waitcnt lgkmcnt(1)
    v_mul_u32_u24_sdwa v2, v2, v17 dst_sel:DWORD dst_unused:UNUSED_PAD src0_sel:WORD_0 src1_sel:DWORD
    v_mul_u32_u24_sdwa v3, v3, v17 dst_sel:DWORD dst_unused:UNUSED_PAD src0_sel:WORD_0 src1_sel:DWORD
    s_mov_b32 s84, 0
    s_mov_b32 s85, 256
    s_setprio 3
    v_add_u32_dpp v13, v2, v16 row_newbcast:0 row_mask:0xf bank_mask:0xf
    buffer_load_dwordx4 v[72:75], v13, s[4:7], 0 offen
    v_add_u32_dpp v14, v2, v16 row_newbcast:1 row_mask:0xf bank_mask:0xf
    buffer_load_dwordx4 v[76:79], v14, s[4:7], 0 offen
    v_add_u32_dpp v13, v2, v16 row_newbcast:2 row_mask:0xf bank_mask:0xf
    buffer_load_dwordx4 v[80:83], v13, s[4:7], 0 offen
    v_add_u32_dpp v14, v2, v16 row_newbcast:3 row_mask:0xf bank_mask:0xf
    buffer_load_dwordx4 v[84:87], v14, s[4:7], 0 offen
    v_add_u32_dpp v13, v2, v16 row_newbcast:4 row_mask:0xf bank_mask:0xf
    buffer_load_dwordx4 v[88:91], v13, s[4:7], 0 offen
    v_add_u32_dpp v14, v2, v16 row_newbcast:5 row_mask:0xf bank_mask:0xf
    buffer_load_dwordx4 v[92:95], v14, s[4:7], 0 offen
    v_add_u32_dpp v13, v2, v16 row_newbcast:6 row_mask:0xf bank_mask:0xf
    buffer_load_dwordx4 v[96:99], v13, s[4:7], 0 offen
    v_add_u32_dpp v14, v2, v16 row_newbcast:7 row_mask:0xf bank_mask:0xf
    buffer_load_dwordx4 v[100:103], v14, s[4:7], 0 offen
    s_cmp_le_u32 s52, 320
    s_cbranch_scc1 L_nx0
    v_add_u32_dpp v13, v3, v16 row_newbcast:4 row_mask:0xf bank_mask:0xf
    buffer_load_dwordx4 v[104:107], v13, s[4:7], 0 offen
    v_add_u32_dpp v14, v3, v16 row_newbcast:5 row_mask:0xf bank_mask:0xf
    buffer_load_dwordx4 v[108:111], v14, s[4:7], 0 offen
    v_add_u32_dpp v13, v3, v16 row_newbcast:6 row_mask:0xf bank_mask:0xf
    buffer_load_dwordx4 v[112:115], v13, s[4:7], 0 offen
    v_add_u32_dpp v14, v3, v16 row_newbcast:7 row_mask:0xf bank_mask:0xf
    buffer_load_dwordx4 v[116:119], v14, s[4:7], 0 offen
L_nx0:
    s_cmp_eq_u32 s15, 0
    s_cselect_b32 s48, -1, 0
    v_and_b32 v27, s48, v15
    v_lshl_or_b32 v24, v27, 6, v1
    v_mov_b32 v25, 0
    v_add_u32_dpp v26, v27, v27 row_shl:8 row_mask:0xf bank_mask:0xf
    v_readlane_b32 s16, v24, 16
    v_readlane_b32 s17, v24, 17
    v_readlane_b32 s18, v24, 18
    v_readlane_b32 s19, v24, 19
    v_readlane_b32 s20, v24, 20
    v_readlane_b32 s21, v24, 21
    v_readlane_b32 s22, v24, 22
    v_readlane_b32 s23, v24, 23
    v_readlane_b32 s24, v24, 24
    v_readlane_b32 s25, v24, 25
    v_readlane_b32 s26, v24, 26
    v_readlane_b32 s27, v24, 27
    v_readlane_b32 s28, v24, 28
    v_readlane_b32 s29, v24, 29
    v_readlane_b32 s30, v24, 30
    v_readlane_b32 s31, v24, 31
    v_readlane_b32 s32, v24, 32
    v_readlane_b32 s33, v24, 33
    v_readlane_b32 s34, v24, 34
    v_readlane_b32 s35, v24, 35
    v_readlane_b32 s36, v24, 36
    v_readlane_b32 s37, v24, 37
    v_readlane_b32 s38, v24, 38
    v_readlane_b32 s39, v24, 39
    v_lshl_or_b32 v26, v26, 3, v1
    v_cmp_gt_u32 s[40:41], s16, v24
    v_cmp_gt_u32 s[42:43], s17, v24
    v_cmp_gt_u32 s[44:45], s18, v24
    v_addc_co_u32 v25, vcc, 0, v25, s[40:41]
    v_addc_co_u32 v25, vcc, 0, v25, s[42:43]
    v_addc_co_u32 v25, vcc, 0, v25, s[44:45]
    v_cmp_gt_u32 s[40:41], s19, v24
    v_cmp_gt_u32 s[42:43], s20, v24
    v_cmp_gt_u32 s[44:45], s21, v24
    v_addc_co_u32 v25, vcc, 0, v25, s[40:41]
    v_addc_co_u32 v25, vcc, 0, v25, s[42:43]
    v_addc_co_u32 v25, vcc, 0, v25, s[44:45]
    v_cmp_gt_u32 s[40:41], s22, v24
    v_cmp_gt_u32 s[42:43], s23, v24
    v_cmp_gt_u32 s[44:45], s24, v24
    v_addc_co_u32 v25, vcc, 0, v25, s[40:41]
    v_addc_co_u32 v25, vcc, 0, v25, s[42:43]
    v_addc_co_u32 v25, vcc, 0, v25, s[44:45]
    v_cmp_gt_u32 s[40:41], s25, v24
    v_cmp_gt_u32 s[42:43], s26, v24
    v_cmp_gt_u32 s[44:45], s27, v24
    v_addc_co_u32 v25, vcc, 0, v25, s[40:41]
    v_addc_co_u32 v25, vcc, 0, v25, s[42:43]
    v_addc_co_u32 v25, vcc, 0, v25, s[44:45]
    v_cmp_gt_u32 s[40:41], s28, v24
    v_cmp_gt_u32 s[42:43], s29, v24
    v_cmp_gt_u32 s[44:45], s30, v24
    v_addc_co_u32 v25, vcc, 0, v25, s[40:41]
    v_addc_co_u32 v25, vcc, 0, v25, s[42:43]
    v_addc_co_u32 v25, vcc, 0, v25, s[44:45]
    v_cmp_gt_u32 s[40:41], s31, v24
    v_cmp_gt_u32 s[42:43], s32, v24
    v_cmp_gt_u32 s[44:45], s33, v24
    v_addc_co_u32 v25, vcc, 0, v25, s[40:41]
    v_addc_co_u32 v25, vcc, 0, v25, s[42:43]
    v_addc_co_u32 v25, vcc, 0, v25, s[44:45]
    v_cmp_gt_u32 s[40:41], s34, v24
    v_cmp_gt_u32 s[42:43], s35, v24
    v_cmp_gt_u32 s[44:45], s36, v24
    v_addc_co_u32 v25, vcc, 0, v25, s[40:41]
    v_addc_co_u32 v25, vcc, 0, v25, s[42:43]
    v_addc_co_u32 v25, vcc, 0, v25, s[44:45]
    v_cmp_gt_u32 s[40:41], s37, v24
    v_cmp_gt_u32 s[42:43], s38, v24
    v_cmp_gt_u32 s[44:45], s39, v24
    v_addc_co_u32 v25, vcc, 0, v25, s[40:41]
    v_addc_co_u32 v25, vcc, 0, v25, s[42:43]
    v_addc_co_u32 v25, vcc, 0, v25, s[44:45]
    v_readlane_b32 s48, v26, s14
    s_nop 1
    v_cmp_gt_u32 vcc, s48, v26
    s_and_b32 s48, vcc_lo, 0xff
    s_bcnt1_i32_b32 s48, s48
    v_cmp_eq_u32 vcc, s48, v25
    s_and_b32 vcc_lo, vcc_lo, 0xffff0000
    s_and_b32 vcc_hi, vcc_hi, 0xff
    s_ff1_i32_b64 s42, vcc
    s_add_u32 s48, s48, 8
    v_cmp_eq_u32 vcc, s48, v25
    s_and_b32 vcc_lo, vcc_lo, 0xffff0000
    s_and_b32 vcc_hi, vcc_hi, 0xff
    s_ff1_i32_b64 s41, vcc
    s_add_u32 s48, s48, 8
    v_cmp_eq_u32 vcc, s48, v25
    s_and_b32 vcc_lo, vcc_lo, 0xffff0000
    s_and_b32 vcc_hi, vcc_hi, 0xff
    s_ff1_i32_b64 s40, vcc
    s_add_u32 s48, s48, 8
    s_lshl_b32 s48, s14, 2
    v_mov_b32 v24, s48
    v_readlane_b32 s81, v10, s40
    v_readlane_b32 s54, v15, s40
    s_lshl_b32 s48, s40, 9
    v_add_u32 v12, s81, v18
    v_mov_b32 v25, s48
    v_readlane_b32 s82, v10, s41
    v_readlane_b32 s55, v15, s41
    s_lshl_b32 s48, s41, 9
    v_add_u32 v13, s82, v18
    v_mov_b32 v26, s48
    v_readlane_b32 s83, v10, s42
    v_readlane_b32 s56, v15, s42
    s_lshl_b32 s48, s42, 9
    v_add_u32 v14, s83, v18
    v_mov_b32 v27, s48
    ds_read2st64_b32 v[6:7], v12 offset0:0 offset1:1
    ds_read2st64_b32 v[8:9], v13 offset0:0 offset1:1
    ds_read2st64_b32 v[10:11], v14 offset0:0 offset1:1
    s_mov_b64 exec, 1
    ds_write_b32 v24, v25 offset:640
    ds_write_b32 v24, v26 offset:576
    ds_write_b32 v24, v27 offset:608
    s_mov_b64 exec, -1
    v_mov_b32 v32, 0
    v_mov_b32 v33, 0
    v_mov_b32 v34, 0
    v_mov_b32 v35, 0
    v_mov_b32 v36, 0
    v_mov_b32 v37, 0
    v_mov_b32 v38, 0
    v_mov_b32 v39, 0
    v_mov_b32 v40, 0
    v_mov_b32 v41, 0
    v_mov_b32 v42, 0
    v_mov_b32 v43, 0
    v_mov_b32 v44, 0
    v_mov_b32 v45, 0
    v_mov_b32 v46, 0
    v_mov_b32 v47, 0
    v_mov_b32 v48, 0
    v_mov_b32 v49, 0
    v_mov_b32 v50, 0
    v_mov_b32 v51, 0
    v_mov_b32 v52, 0
    v_mov_b32 v53, 0
    v_mov_b32 v54, 0
    v_mov_b32 v55, 0
    v_mov_b32 v56, 0
    v_mov_b32 v57, 0
    v_mov_b32 v58, 0
    v_mov_b32 v59, 0
    v_mov_b32 v60, 0
    v_mov_b32 v61, 0
    v_mov_b32 v62, 0
    v_mov_b32 v63, 0
    v_mov_b32 v64, 0
    v_mov_b32 v65, 0
    v_mov_b32 v66, 0
    v_mov_b32 v67, 0
    v_mov_b32 v68, 0
    v_mov_b32 v69, 0
    v_mov_b32 v70, 0
    v_mov_b32 v71, 0
    s_lshl_b32 s79, s79, 1
    s_lshl_b32 s16, s14, 11
    s_add_u32 s16, s16, 74496
    s_add_u32 s21, s14, 0
    s_mov_b32 s26, 320
    s_lshl_b32 s80, s80, 1
    s_lshl_b32 s17, s14, 11
    s_add_u32 s17, s17, 90880
    s_add_u32 s22, s14, 8
    s_mov_b32 s27, 320
    s_lshl_b32 s81, s81, 1
    s_lshl_b32 s18, s14, 11
    s_add_u32 s18, s18, 140032
    s_add_u32 s23, s14, 0
    s_mov_b32 s28, 328
    s_lshl_b32 s82, s82, 1
    s_lshl_b32 s19, s14, 11
    s_add_u32 s19, s19, 107264
    s_add_u32 s24, s14, 0
    s_mov_b32 s29, 324
    s_lshl_b32 s83, s83, 1
    s_lshl_b32 s20, s14, 11
    s_add_u32 s20, s20, 123648
    s_add_u32 s25, s14, 8
    s_mov_b32 s30, 324
    s_mov_b32 s86, s52
    s_waitcnt lgkmcnt(0)
    v_mul_u32_u24_sdwa v4, v4, v17 dst_sel:DWORD dst_unused:UNUSED_PAD src0_sel:WORD_0 src1_sel:DWORD
    v_mul_u32_u24_sdwa v5, v5, v17 dst_sel:DWORD dst_unused:UNUSED_PAD src0_sel:WORD_0 src1_sel:DWORD
    v_mul_u32_u24_sdwa v6, v6, v17 dst_sel:DWORD dst_unused:UNUSED_PAD src0_sel:WORD_0 src1_sel:DWORD
    v_mul_u32_u24_sdwa v7, v7, v17 dst_sel:DWORD dst_unused:UNUSED_PAD src0_sel:WORD_0 src1_sel:DWORD
    v_mul_u32_u24_sdwa v8, v8, v17 dst_sel:DWORD dst_unused:UNUSED_PAD src0_sel:WORD_0 src1_sel:DWORD
    v_mul_u32_u24_sdwa v9, v9, v17 dst_sel:DWORD dst_unused:UNUSED_PAD src0_sel:WORD_0 src1_sel:DWORD
    v_mul_u32_u24_sdwa v10, v10, v17 dst_sel:DWORD dst_unused:UNUSED_PAD src0_sel:WORD_0 src1_sel:DWORD
    v_mul_u32_u24_sdwa v11, v11, v17 dst_sel:DWORD dst_unused:UNUSED_PAD src0_sel:WORD_0 src1_sel:DWORD
    s_branch L_hloop
L_pub:
    s_cmp_eq_u32 s14, 0
    s_cbranch_scc1 L_pub0
    v_mov_b32 v56, v58
    v_mov_b32 v57, v59
    v_mov_b32 v60, v62
    v_mov_b32 v61, v63
    v_add_u32 v26, 8, v26
L_pub0:
    v_lshl_or_b32 v16, v56, 12, v60
    v_or_b32 v16, s74, v16
    v_lshl_or_b32 v18, v57, 12, v61
    v_or_b32 v18, s74, v18
    v_mov_b32 v20, s2
    v_lshrrev_b32 v21, 6, v20
    v_lshlrev_b32 v21, 5, v21
    v_and_or_b32 v21, v20, 31, v21
    v_mul_u32_u24 v21, 4224, v21
    v_bfe_u32 v22, v20, 5, 1
    v_lshl_add_u32 v22, v22, 6, v21
    v_and_b32 v21, 63, v68
    v_sub_u32 v20, v68, v21
    v_mad_u32_u24 v20, v20, 2, v21
    v_add_u32 v22, v22, v20
    v_add_u32 v22, 8388608, v22
    s_waitcnt lgkmcnt(0)
    s_barrier
    ds_read_b64 v[20:21], v26 offset:1024
    ds_read_b128 v[32:35], v5
    ds_read_b128 v[8:11], v5 offset:10240
    ds_read_b128 v[12:15], v5 offset:20480
    s_waitcnt lgkmcnt(3)
    v_add_u32 v17, s73, v20
    v_add_u32 v19, s73, v21
    global_store_dwordx4 v22, v[16:19], s[8:9] sc1
    s_branch L_pubd
L_p89:
    s_lshl_b32 s48, s2, 7
    s_add_u32 s48, s48, 9961472
    v_mov_b32 v30, s48
    v_mov_b32 v48, s73
    v_not_b32 v49, v48
    s_waitcnt vmcnt(0)
    s_barrier
    s_cmp_lg_u32 s14, 8
    s_cbranch_scc1 L_gemm
    s_mov_b64 exec, 1
    global_store_dwordx2 v30, v[48:49], s[8:9] sc1
    s_mov_b64 exec, -1
    s_branch L_gemm
L_helper:
    v_mov_b32 v65, 0
    v_mov_b32 v66, 0
    v_mov_b32 v67, 0
    v_lshlrev_b32 v68, 4, v0
    ds_write_b128 v68, v[64:67] offset:1024
    ds_write_b128 v68, v[64:67] offset:13312
    ds_write_b128 v68, v[64:67] offset:25600
    ds_write_b128 v68, v[64:67] offset:37888
    ds_write_b128 v68, v[64:67] offset:50176
    ds_write_b128 v68, v[64:67] offset:62464
    v_and_b32 v2, 15, v0
    v_lshrrev_b32 v3, 4, v1
    s_and_b32 s3, s2, 7
    s_lshl_b32 s3, s3, 5
    s_lshr_b32 s12, s2, 3
    s_add_u32 s3, s3, s12
    s_mov_b32 s6, 5120000
    s_mov_b32 s7, 0x20000
    s_mul_i32 s12, s3, 625
    s_add_u32 s13, s12, 640
    s_add_u32 s12, s12, 15
    s_lshr_b32 s12, s12, 4
    s_lshr_b32 s13, s13, 4
    s_sub_u32 s13, s13, s12
    s_mov_b32 s15, 0
    s_mov_b32 s60, 0
    s_mov_b32 s61, 0
    s_lshr_b32 s75, s3, 2
    s_lshl_b32 s75, s75, 4
    s_and_b32 s58, s3, 1
    s_lshl_b32 s58, s58, 3
    s_add_u32 s75, s75, s58
    s_and_b32 s58, s3, 2
    s_lshl_b32 s58, s58, 9
    s_add_u32 s75, s75, s58
    s_and_b32 s58, s75, 63
    s_sub_u32 s75, s75, s58
    s_mul_i32 s75, s75, 2
    s_add_u32 s75, s75, s58
    s_add_u32 s75, s75, 8388608
    v_lshlrev_b32 v5, 4, v1
    s_cmp_eq_u32 s14, 11
    s_cbranch_scc1 L_h11
    s_waitcnt lgkmcnt(0)
    s_barrier
    v_add_u32 v6, 0, v5
    global_load_dwordx4 v[72:75], v6, s[26:27] offset:0
    global_load_dwordx4 v[76:79], v6, s[26:27] offset:1024
    global_load_dwordx4 v[80:83], v6, s[26:27] offset:2048
    global_load_dwordx4 v[84:87], v6, s[26:27] offset:3072
    v_add_u32 v6, 4096, v5
    global_load_dwordx4 v[88:91], v6, s[26:27] offset:0
    global_load_dwordx4 v[92:95], v6, s[26:27] offset:1024
    global_load_dwordx4 v[96:99], v6, s[26:27] offset:2048
    global_load_dwordx4 v[100:103], v6, s[26:27] offset:3072
    v_add_u32 v6, 8192, v5
    global_load_dwordx4 v[104:107], v6, s[26:27] offset:0
    global_load_dwordx4 v[108:111], v6, s[26:27] offset:1024
    global_load_dwordx4 v[112:115], v6, s[26:27] offset:2048
    global_load_dwordx4 v[116:119], v6, s[26:27] offset:3072
    v_add_u32 v6, 12288, v5
    global_load_dwordx4 v[120:123], v6, s[26:27] offset:0
    global_load_dwordx4 v[124:127], v6, s[26:27] offset:1024
    global_load_dwordx4 v[128:131], v6, s[26:27] offset:2048
    global_load_dwordx4 v[132:135], v6, s[26:27] offset:3072
    v_add_u32 v6, 0, v5
    global_load_dwordx4 v[136:139], v6, s[28:29] offset:0
    global_load_dwordx4 v[140:143], v6, s[28:29] offset:1024
    global_load_dwordx4 v[144:147], v6, s[28:29] offset:2048
    global_load_dwordx4 v[148:151], v6, s[28:29] offset:3072
    v_add_u32 v7, 119808, v5
    s_branch L_h2
L_h11:
    v_mul_u32_u24 v33, 1216, v1
    v_add_u32 v32, 1292, v33
    v_add_u32 v34, 1900, v33
    v_add_u32 v35, 1904, v33
    v_add_u32 v33, 1296, v33
    v_cmp_gt_u32 vcc, 20, v1
    v_lshlrev_b32 v12, 4, v1
    s_nop 0
    v_cndmask_b32 v32, 0, v32, vcc
    v_cndmask_b32 v33, 0, v33, vcc
    v_cndmask_b32 v34, 0, v34, vcc
    v_cndmask_b32 v35, 0, v35, vcc
    ds_write_b128 v12, v[32:35]
    s_waitcnt lgkmcnt(0)
    s_barrier
    v_add_u32 v6, 4096, v5
    global_load_dwordx4 v[72:75], v6, s[28:29] offset:0
    global_load_dwordx4 v[76:79], v6, s[28:29] offset:1024
    global_load_dwordx4 v[80:83], v6, s[28:29] offset:2048
    global_load_dwordx4 v[84:87], v6, s[28:29] offset:3072
    v_add_u32 v6, 8192, v5
    global_load_dwordx4 v[88:91], v6, s[28:29] offset:0
    global_load_dwordx4 v[92:95], v6, s[28:29] offset:1024
    global_load_dwordx4 v[96:99], v6, s[28:29] offset:2048
    global_load_dwordx4 v[100:103], v6, s[28:29] offset:3072
    v_add_u32 v6, 12288, v5
    global_load_dwordx4 v[104:107], v6, s[28:29] offset:0
    global_load_dwordx4 v[108:111], v6, s[28:29] offset:1024
    global_load_dwordx4 v[112:115], v6, s[28:29] offset:2048
    global_load_dwordx4 v[116:119], v6, s[28:29] offset:3072
    v_add_u32 v6, 16384, v5
    global_load_dwordx4 v[120:123], v6, s[28:29] offset:0
    global_load_dwordx4 v[124:127], v6, s[28:29] offset:1024
    global_load_dwordx4 v[128:131], v6, s[28:29] offset:2048
    global_load_dwordx4 v[132:135], v6, s[28:29] offset:3072
    v_add_u32 v6, 20480, v5
    global_load_dwordx4 v[136:139], v6, s[28:29] offset:0
    global_load_dwordx4 v[140:143], v6, s[28:29] offset:1024
    global_load_dwordx4 v[144:147], v6, s[28:29] offset:2048
    global_load_dwordx4 v[148:151], v6, s[28:29] offset:3072
    v_add_u32 v7, 140288, v5
L_h2:
    v_min_u32 v6, 624, v5
    global_load_dwordx4 v[152:155], v6, s[24:25]
    s_barrier
    s_waitcnt vmcnt(0)
    ds_write_b128 v7, v[72:75] offset:0
    ds_write_b128 v7, v[76:79] offset:1024
    ds_write_b128 v7, v[80:83] offset:2048
    ds_write_b128 v7, v[84:87] offset:3072
    ds_write_b128 v7, v[88:91] offset:4096
    ds_write_b128 v7, v[92:95] offset:5120
    ds_write_b128 v7, v[96:99] offset:6144
    ds_write_b128 v7, v[100:103] offset:7168
    ds_write_b128 v7, v[104:107] offset:8192
    ds_write_b128 v7, v[108:111] offset:9216
    ds_write_b128 v7, v[112:115] offset:10240
    ds_write_b128 v7, v[116:119] offset:11264
    ds_write_b128 v7, v[120:123] offset:12288
    ds_write_b128 v7, v[124:127] offset:13312
    ds_write_b128 v7, v[128:131] offset:14336
    ds_write_b128 v7, v[132:135] offset:15360
    ds_write_b128 v7, v[136:139] offset:16384
    ds_write_b128 v7, v[140:143] offset:17408
    ds_write_b128 v7, v[144:147] offset:18432
    ds_write_b128 v7, v[148:151] offset:19456
    v_add_u32 v7, 160768, v5
    ds_write_b128 v7, v[152:155]
    s_waitcnt lgkmcnt(0)
    s_barrier
L_gemm:
    s_sub_u32 s51, s14, 8
    v_and_b32 v9, 7, v2
    v_add_u32 v8, 0, v3
    v_xor_b32 v8, v8, v2
    v_lshlrev_b32 v8, 4, v8
    v_lshl_add_u32 v8, v2, 11, v8
    v_add_u32 v16, 74496, v8
    v_add_u32 v8, 0, v3
    v_xor_b32 v8, v8, v9
    v_lshlrev_b32 v8, 4, v8
    v_lshl_add_u32 v8, v9, 11, v8
    v_add_u32 v20, 140032, v8
    v_add_u32 v8, 4, v3
    v_xor_b32 v8, v8, v2
    v_lshlrev_b32 v8, 4, v8
    v_lshl_add_u32 v8, v2, 11, v8
    v_add_u32 v17, 74496, v8
    v_add_u32 v8, 4, v3
    v_xor_b32 v8, v8, v9
    v_lshlrev_b32 v8, 4, v8
    v_lshl_add_u32 v8, v9, 11, v8
    v_add_u32 v21, 140032, v8
    v_add_u32 v8, 8, v3
    v_xor_b32 v8, v8, v2
    v_lshlrev_b32 v8, 4, v8
    v_lshl_add_u32 v8, v2, 11, v8
    v_add_u32 v18, 74496, v8
    v_add_u32 v8, 8, v3
    v_xor_b32 v8, v8, v9
    v_lshlrev_b32 v8, 4, v8
    v_lshl_add_u32 v8, v9, 11, v8
    v_add_u32 v22, 140032, v8
    v_add_u32 v8, 12, v3
    v_xor_b32 v8, v8, v2
    v_lshlrev_b32 v8, 4, v8
    v_lshl_add_u32 v8, v2, 11, v8
    v_add_u32 v19, 74496, v8
    v_add_u32 v8, 12, v3
    v_xor_b32 v8, v8, v9
    v_lshlrev_b32 v8, 4, v8
    v_lshl_add_u32 v8, v9, 11, v8
    v_add_u32 v23, 140032, v8
    v_mul_u32_u24 v5, 528, v2
    v_lshl_add_u32 v5, v3, 3, v5
    s_lshl_b32 s48, s51, 5
    s_add_u32 s48, s48, 1024
    v_add_u32 v5, s48, v5
    v_lshrrev_b32 v6, 5, v1
    v_lshlrev_b32 v6, 4, v6
    v_lshl_add_u32 v6, v1, 4, v6
    v_add_u32 v6, 1024, v6
    v_lshlrev_b32 v7, 4, v1
    s_mov_b32 s40, s10
    s_mov_b32 s41, s11
    s_add_u32 s42, s12, s13
    s_lshl_b32 s42, s42, 9
    s_mov_b32 s43, 0x20000
    s_lshl_b32 s44, s12, 9
    v_mov_b32 v14, 0
    v_mov_b32 v12, 1
    s_mov_b32 s45, 0xbfb8aa3b
    s_lshl_b32 s48, s51, 5
    s_add_u32 s48, s48, 119808
    v_lshrrev_b32 v28, 2, v2
    v_lshl_add_u32 v28, v3, 3, v28
    v_lshlrev_b32 v28, 7, v28
    v_and_b32 v29, 3, v2
    v_lshl_add_u32 v28, v29, 3, v28
    v_add_u32 v28, s48, v28
    v_lshlrev_b32 v29, 4, v3
    v_add_u32 v29, 160768, v29
    ds_read_b64_tr_b16 v[32:33], v28 offset:0
    ds_read_b64_tr_b16 v[34:35], v28 offset:512
    ds_read_b128 v[128:131], v29 offset:0
    ds_read_b64_tr_b16 v[36:37], v28 offset:4096
    ds_read_b64_tr_b16 v[38:39], v28 offset:4608
    ds_read_b128 v[132:135], v29 offset:64
    ds_read_b64_tr_b16 v[40:41], v28 offset:8192
    ds_read_b64_tr_b16 v[42:43], v28 offset:8704
    ds_read_b128 v[136:139], v29 offset:128
    ds_read_b64_tr_b16 v[44:45], v28 offset:12288
    ds_read_b64_tr_b16 v[46:47], v28 offset:12800
    ds_read_b128 v[140:143], v29 offset:192
    ds_read_b64_tr_b16 v[48:49], v28 offset:16384
    ds_read_b64_tr_b16 v[50:51], v28 offset:16896
    ds_read_b128 v[144:147], v29 offset:256
    ds_read_b64_tr_b16 v[52:53], v28 offset:20480
    ds_read_b64_tr_b16 v[54:55], v28 offset:20992
    ds_read_b128 v[148:151], v29 offset:320
    ds_read_b64_tr_b16 v[56:57], v28 offset:24576
    ds_read_b64_tr_b16 v[58:59], v28 offset:25088
    ds_read_b128 v[152:155], v29 offset:384
    ds_read_b64_tr_b16 v[60:61], v28 offset:28672
    ds_read_b64_tr_b16 v[62:63], v28 offset:29184
    ds_read_b128 v[156:159], v29 offset:448
    ds_read_b64_tr_b16 v[64:65], v28 offset:32768
    ds_read_b64_tr_b16 v[66:67], v28 offset:33280
    ds_read_b128 v[160:163], v29 offset:512
    ds_read_b64_tr_b16 v[68:69], v28 offset:36864
    ds_read_b64_tr_b16 v[70:71], v28 offset:37376
    ds_read_b128 v[164:167], v29 offset:576
    s_mov_b32 s66, 1
L_gplaced:
    v_lshlrev_b32 v8, 3, v1
    v_mul_u32_u24 v9, 608, v1
    v_add_u32 v9, 1296, v9
    s_waitcnt lgkmcnt(0)
    s_barrier
    ds_read_b64 v[10:11], v8 offset:0
    s_waitcnt lgkmcnt(0)
    v_readlane_b32 s65, v10, 46
    v_add_u32 v10, 4, v10
    v_sub_u32 v15, v11, v10
    s_cmp_lg_u32 s15, 0
    s_cbranch_scc1 L_m_ok
    v_sub_u32 v11, v11, v9
    v_sub_u32 v9, v9, v10
    v_max_u32 v9, v9, v11
    v_cmp_lt_u32 vcc, 272, v9
    v_mov_b32 v9, 512
    v_cmp_lt_u32 s[48:49], v9, v15
    s_or_b64 vcc, vcc, s[48:49]
    s_and_b32 vcc_hi, vcc_hi, 0xff
    s_or_b32 s48, vcc_lo, vcc_hi
    s_or_b32 s48, s48, s65
    s_cmp_eq_u32 s48, 0
    s_cbranch_scc1 L_m_ok
    s_mov_b32 s15, 1
    s_max_u32 s64, s65, 32
    s_min_u32 s64, s64, 2560
    s_waitcnt vmcnt(0) lgkmcnt(0)
    s_barrier
    s_branch L_gnext
L_m_ok:
    s_branch L_stages
L_late:
L_hloop:
    v_add_u32 v22, s79, v19
    ds_read_u16 v12, v22 offset:0
    ds_read_u16 v13, v22 offset:64
    ds_read_u16 v14, v22 offset:8
    ds_read_u16 v15, v22 offset:72
    ds_read_u16 v24, v22 offset:128
    ds_read_u16 v25, v22 offset:192
    ds_read_u16 v26, v22 offset:136
    ds_read_u16 v27, v22 offset:200
    s_cmp_gt_u32 s52, 320
    s_cbranch_scc1 L_xa0
L_na0:
    s_setprio 3
    s_cmp_eq_u32 s53, 0
    s_cbranch_scc1 L_w0_0
    v_add_u32_dpp v17, v4, v16 row_newbcast:0 row_mask:0xf bank_mask:0xf
    buffer_load_dwordx4 v[120:123], v17, s[4:7], s84 offen
    v_add_u32_dpp v18, v4, v16 row_newbcast:1 row_mask:0xf bank_mask:0xf
    buffer_load_dwordx4 v[124:127], v18, s[4:7], s84 offen
    v_add_u32_dpp v17, v4, v16 row_newbcast:2 row_mask:0xf bank_mask:0xf
    buffer_load_dwordx4 v[128:131], v17, s[4:7], s84 offen
    v_add_u32_dpp v18, v4, v16 row_newbcast:3 row_mask:0xf bank_mask:0xf
    buffer_load_dwordx4 v[132:135], v18, s[4:7], s84 offen
    v_add_u32_dpp v17, v4, v16 row_newbcast:4 row_mask:0xf bank_mask:0xf
    buffer_load_dwordx4 v[136:139], v17, s[4:7], s84 offen
    v_add_u32_dpp v18, v4, v16 row_newbcast:5 row_mask:0xf bank_mask:0xf
    buffer_load_dwordx4 v[140:143], v18, s[4:7], s84 offen
    v_add_u32_dpp v17, v4, v16 row_newbcast:6 row_mask:0xf bank_mask:0xf
    buffer_load_dwordx4 v[144:147], v17, s[4:7], s84 offen
    v_add_u32_dpp v18, v4, v16 row_newbcast:7 row_mask:0xf bank_mask:0xf
    buffer_load_dwordx4 v[148:151], v18, s[4:7], s84 offen
    s_cmp_gt_u32 s53, 320
    s_cbranch_scc1 L_xl0
    s_waitcnt vmcnt(8) lgkmcnt(0)
L_go0:
    v_swap_b32 v74, v80
    v_swap_b32 v75, v81
    v_swap_b32 v78, v84
    v_swap_b32 v79, v85
    v_swap_b32 v90, v96
    v_swap_b32 v91, v97
    v_swap_b32 v94, v100
    v_swap_b32 v95, v101
    v_smfmac_f32_16x16x64_bf16 v[32:35], v[12:15], v[72:79], v20
    v_smfmac_f32_16x16x64_bf16 v[36:39], v[12:15], v[80:87], v20
    v_smfmac_f32_16x16x64_bf16 v[32:35], v[24:27], v[88:95], v20
    v_smfmac_f32_16x16x64_bf16 v[36:39], v[24:27], v[96:103], v20
    s_cmp_gt_u32 s52, 320
    s_cbranch_scc1 L_xm0
L_md0:
    v_add_u32 v22, s80, v19
    ds_read_u16 v12, v22 offset:0
    ds_read_u16 v13, v22 offset:64
    ds_read_u16 v14, v22 offset:8
    ds_read_u16 v15, v22 offset:72
    ds_read_u16 v24, v22 offset:128
    ds_read_u16 v25, v22 offset:192
    ds_read_u16 v26, v22 offset:136
    ds_read_u16 v27, v22 offset:200
    s_cmp_gt_u32 s53, 320
    s_cbranch_scc1 L_xa1
L_na1:
    s_setprio 3
    s_cmp_ge_u32 s14, 4
    s_cbranch_scc1 L_pr1
    s_setprio 2
L_pr1:
    s_cmp_eq_u32 s54, 0
    s_cbranch_scc1 L_w1_0
    v_add_u32_dpp v17, v6, v16 row_newbcast:0 row_mask:0xf bank_mask:0xf
    buffer_load_dwordx4 v[72:75], v17, s[4:7], s84 offen
    v_add_u32_dpp v18, v6, v16 row_newbcast:1 row_mask:0xf bank_mask:0xf
    buffer_load_dwordx4 v[76:79], v18, s[4:7], s84 offen
    v_add_u32_dpp v17, v6, v16 row_newbcast:2 row_mask:0xf bank_mask:0xf
    buffer_load_dwordx4 v[80:83], v17, s[4:7], s84 offen
    v_add_u32_dpp v18, v6, v16 row_newbcast:3 row_mask:0xf bank_mask:0xf
    buffer_load_dwordx4 v[84:87], v18, s[4:7], s84 offen
    v_add_u32_dpp v17, v6, v16 row_newbcast:4 row_mask:0xf bank_mask:0xf
    buffer_load_dwordx4 v[88:91], v17, s[4:7], s84 offen
    v_add_u32_dpp v18, v6, v16 row_newbcast:5 row_mask:0xf bank_mask:0xf
    buffer_load_dwordx4 v[92:95], v18, s[4:7], s84 offen
    v_add_u32_dpp v17, v6, v16 row_newbcast:6 row_mask:0xf bank_mask:0xf
    buffer_load_dwordx4 v[96:99], v17, s[4:7], s84 offen
    v_add_u32_dpp v18, v6, v16 row_newbcast:7 row_mask:0xf bank_mask:0xf
    buffer_load_dwordx4 v[100:103], v18, s[4:7], s84 offen
    s_cmp_gt_u32 s54, 320
    s_cbranch_scc1 L_xl1
    s_waitcnt vmcnt(8) lgkmcnt(0)
L_go1:
    v_swap_b32 v122, v128
    v_swap_b32 v123, v129
    v_swap_b32 v126, v132
    v_swap_b32 v127, v133
    v_swap_b32 v138, v144
    v_swap_b32 v139, v145
    v_swap_b32 v142, v148
    v_swap_b32 v143, v149
    v_smfmac_f32_16x16x64_bf16 v[40:43], v[12:15], v[120:127], v20
    v_smfmac_f32_16x16x64_bf16 v[44:47], v[12:15], v[128:135], v20
    v_smfmac_f32_16x16x64_bf16 v[40:43], v[24:27], v[136:143], v20
    v_smfmac_f32_16x16x64_bf16 v[44:47], v[24:27], v[144:151], v20
    s_cmp_gt_u32 s53, 320
    s_cbranch_scc1 L_xm1
L_md1:
    v_add_u32 v22, s81, v19
    ds_read_u16 v12, v22 offset:0
    ds_read_u16 v13, v22 offset:64
    ds_read_u16 v14, v22 offset:8
    ds_read_u16 v15, v22 offset:72
    ds_read_u16 v24, v22 offset:128
    ds_read_u16 v25, v22 offset:192
    ds_read_u16 v26, v22 offset:136
    ds_read_u16 v27, v22 offset:200
    s_cmp_gt_u32 s54, 320
    s_cbranch_scc1 L_xa2
L_na2:
    s_setprio 2
    s_cmp_eq_u32 s55, 0
    s_cbranch_scc1 L_w2_0
    v_add_u32_dpp v17, v8, v16 row_newbcast:0 row_mask:0xf bank_mask:0xf
    buffer_load_dwordx4 v[120:123], v17, s[4:7], s84 offen
    v_add_u32_dpp v18, v8, v16 row_newbcast:1 row_mask:0xf bank_mask:0xf
    buffer_load_dwordx4 v[124:127], v18, s[4:7], s84 offen
    v_add_u32_dpp v17, v8, v16 row_newbcast:2 row_mask:0xf bank_mask:0xf
    buffer_load_dwordx4 v[128:131], v17, s[4:7], s84 offen
    v_add_u32_dpp v18, v8, v16 row_newbcast:3 row_mask:0xf bank_mask:0xf
    buffer_load_dwordx4 v[132:135], v18, s[4:7], s84 offen
    v_add_u32_dpp v17, v8, v16 row_newbcast:4 row_mask:0xf bank_mask:0xf
    buffer_load_dwordx4 v[136:139], v17, s[4:7], s84 offen
    v_add_u32_dpp v18, v8, v16 row_newbcast:5 row_mask:0xf bank_mask:0xf
    buffer_load_dwordx4 v[140:143], v18, s[4:7], s84 offen
    v_add_u32_dpp v17, v8, v16 row_newbcast:6 row_mask:0xf bank_mask:0xf
    buffer_load_dwordx4 v[144:147], v17, s[4:7], s84 offen
    v_add_u32_dpp v18, v8, v16 row_newbcast:7 row_mask:0xf bank_mask:0xf
    buffer_load_dwordx4 v[148:151], v18, s[4:7], s84 offen
    s_cmp_gt_u32 s55, 320
    s_cbranch_scc1 L_xl2
    s_waitcnt vmcnt(8) lgkmcnt(0)
L_go2:
    v_swap_b32 v74, v80
    v_swap_b32 v75, v81
    v_swap_b32 v78, v84
    v_swap_b32 v79, v85
    v_swap_b32 v90, v96
    v_swap_b32 v91, v97
    v_swap_b32 v94, v100
    v_swap_b32 v95, v101
    v_smfmac_f32_16x16x64_bf16 v[48:51], v[12:15], v[72:79], v20
    v_smfmac_f32_16x16x64_bf16 v[52:55], v[12:15], v[80:87], v20
    v_smfmac_f32_16x16x64_bf16 v[48:51], v[24:27], v[88:95], v20
    v_smfmac_f32_16x16x64_bf16 v[52:55], v[24:27], v[96:103], v20
    s_cmp_gt_u32 s54, 320
    s_cbranch_scc1 L_xm2
L_md2:
    v_add_u32 v22, s82, v19
    ds_read_u16 v12, v22 offset:0
    ds_read_u16 v13, v22 offset:64
    ds_read_u16 v14, v22 offset:8
    ds_read_u16 v15, v22 offset:72
    ds_read_u16 v24, v22 offset:128
    ds_read_u16 v25, v22 offset:192
    ds_read_u16 v26, v22 offset:136
    ds_read_u16 v27, v22 offset:200
    s_cmp_gt_u32 s55, 320
    s_cbranch_scc1 L_xa3
L_na3:
    s_setprio 2
    s_cmp_eq_u32 s56, 0
    s_cbranch_scc1 L_w3_0
    v_add_u32_dpp v17, v10, v16 row_newbcast:0 row_mask:0xf bank_mask:0xf
    buffer_load_dwordx4 v[72:75], v17, s[4:7], s84 offen
    v_add_u32_dpp v18, v10, v16 row_newbcast:1 row_mask:0xf bank_mask:0xf
    buffer_load_dwordx4 v[76:79], v18, s[4:7], s84 offen
    v_add_u32_dpp v17, v10, v16 row_newbcast:2 row_mask:0xf bank_mask:0xf
    buffer_load_dwordx4 v[80:83], v17, s[4:7], s84 offen
    v_add_u32_dpp v18, v10, v16 row_newbcast:3 row_mask:0xf bank_mask:0xf
    buffer_load_dwordx4 v[84:87], v18, s[4:7], s84 offen
    v_add_u32_dpp v17, v10, v16 row_newbcast:4 row_mask:0xf bank_mask:0xf
    buffer_load_dwordx4 v[88:91], v17, s[4:7], s84 offen
    v_add_u32_dpp v18, v10, v16 row_newbcast:5 row_mask:0xf bank_mask:0xf
    buffer_load_dwordx4 v[92:95], v18, s[4:7], s84 offen
    v_add_u32_dpp v17, v10, v16 row_newbcast:6 row_mask:0xf bank_mask:0xf
    buffer_load_dwordx4 v[96:99], v17, s[4:7], s84 offen
    v_add_u32_dpp v18, v10, v16 row_newbcast:7 row_mask:0xf bank_mask:0xf
    buffer_load_dwordx4 v[100:103], v18, s[4:7], s84 offen
    s_cmp_gt_u32 s56, 320
    s_cbranch_scc1 L_xl3
    s_waitcnt vmcnt(8) lgkmcnt(0)
L_go3:
    v_swap_b32 v122, v128
    v_swap_b32 v123, v129
    v_swap_b32 v126, v132
    v_swap_b32 v127, v133
    v_swap_b32 v138, v144
    v_swap_b32 v139, v145
    v_swap_b32 v142, v148
    v_swap_b32 v143, v149
    v_smfmac_f32_16x16x64_bf16 v[56:59], v[12:15], v[120:127], v20
    v_smfmac_f32_16x16x64_bf16 v[60:63], v[12:15], v[128:135], v20
    v_smfmac_f32_16x16x64_bf16 v[56:59], v[24:27], v[136:143], v20
    v_smfmac_f32_16x16x64_bf16 v[60:63], v[24:27], v[144:151], v20
    s_cmp_gt_u32 s55, 320
    s_cbranch_scc1 L_xm3
L_md3:
    v_add_u32 v22, s83, v19
    ds_read_u16 v12, v22 offset:0
    ds_read_u16 v13, v22 offset:64
    ds_read_u16 v14, v22 offset:8
    ds_read_u16 v15, v22 offset:72
    ds_read_u16 v24, v22 offset:128
    ds_read_u16 v25, v22 offset:192
    ds_read_u16 v26, v22 offset:136
    ds_read_u16 v27, v22 offset:200
    s_cmp_gt_u32 s56, 320
    s_cbranch_scc1 L_xa4
L_na4:
    s_setprio 2
    s_cmp_ge_u32 s14, 4
    s_cbranch_scc1 L_pr4
    s_setprio 1
L_pr4:
    s_cmp_le_u32 s52, 128
    s_cbranch_scc1 L_w4_0
    v_add_u32_dpp v17, v2, v16 row_newbcast:8 row_mask:0xf bank_mask:0xf
    buffer_load_dwordx4 v[120:123], v17, s[4:7], s84 offen
    v_add_u32_dpp v18, v2, v16 row_newbcast:9 row_mask:0xf bank_mask:0xf
    buffer_load_dwordx4 v[124:127], v18, s[4:7], s84 offen
    v_add_u32_dpp v17, v2, v16 row_newbcast:10 row_mask:0xf bank_mask:0xf
    buffer_load_dwordx4 v[128:131], v17, s[4:7], s84 offen
    v_add_u32_dpp v18, v2, v16 row_newbcast:11 row_mask:0xf bank_mask:0xf
    buffer_load_dwordx4 v[132:135], v18, s[4:7], s84 offen
    v_add_u32_dpp v17, v2, v16 row_newbcast:12 row_mask:0xf bank_mask:0xf
    buffer_load_dwordx4 v[136:139], v17, s[4:7], s84 offen
    s_cmp_le_u32 s52, 208
    s_cbranch_scc1 L_w4_5
    v_add_u32_dpp v18, v2, v16 row_newbcast:13 row_mask:0xf bank_mask:0xf
    buffer_load_dwordx4 v[140:143], v18, s[4:7], s84 offen
    s_cmp_le_u32 s52, 224
    s_cbranch_scc1 L_w4_6
    v_add_u32_dpp v17, v2, v16 row_newbcast:14 row_mask:0xf bank_mask:0xf
    buffer_load_dwordx4 v[144:147], v17, s[4:7], s84 offen
    s_cmp_le_u32 s52, 240
    s_cbranch_scc1 L_w4_7
    v_add_u32_dpp v18, v2, v16 row_newbcast:15 row_mask:0xf bank_mask:0xf
    buffer_load_dwordx4 v[148:151], v18, s[4:7], s84 offen
    s_cmp_le_u32 s52, 256
    s_cbranch_scc1 L_w4_8
    v_add_u32_dpp v17, v3, v16 row_newbcast:0 row_mask:0xf bank_mask:0xf
    buffer_load_dwordx4 v[152:155], v17, s[4:7], s84 offen
    s_cmp_le_u32 s52, 272
    s_cbranch_scc1 L_w4_9
    v_add_u32_dpp v18, v3, v16 row_newbcast:1 row_mask:0xf bank_mask:0xf
    buffer_load_dwordx4 v[156:159], v18, s[4:7], s84 offen
    s_cmp_le_u32 s52, 288
    s_cbranch_scc1 L_w4_10
    v_add_u32_dpp v17, v3, v16 row_newbcast:2 row_mask:0xf bank_mask:0xf
    buffer_load_dwordx4 v[160:163], v17, s[4:7], s84 offen
    s_cmp_le_u32 s52, 304
    s_cbranch_scc1 L_w4_11
    v_add_u32_dpp v18, v3, v16 row_newbcast:3 row_mask:0xf bank_mask:0xf
    buffer_load_dwordx4 v[164:167], v18, s[4:7], s84 offen
    s_branch L_w4_12
L_w4_5:
    s_waitcnt vmcnt(5)
L_w4_6:
    s_waitcnt vmcnt(6)
L_w4_7:
    s_waitcnt vmcnt(7)
L_w4_8:
    s_waitcnt vmcnt(8)
L_w4_9:
    s_waitcnt vmcnt(9)
L_w4_10:
    s_waitcnt vmcnt(10)
L_w4_11:
    s_waitcnt vmcnt(11)
L_w4_12:
    s_waitcnt vmcnt(12) lgkmcnt(0)
L_go4:
    v_swap_b32 v74, v80
    v_swap_b32 v75, v81
    v_swap_b32 v78, v84
    v_swap_b32 v79, v85
    v_swap_b32 v90, v96
    v_swap_b32 v91, v97
    v_swap_b32 v94, v100
    v_swap_b32 v95, v101
    v_smfmac_f32_16x16x64_bf16 v[64:67], v[12:15], v[72:79], v20
    v_smfmac_f32_16x16x64_bf16 v[68:71], v[12:15], v[80:87], v20
    v_smfmac_f32_16x16x64_bf16 v[64:67], v[24:27], v[88:95], v20
    v_smfmac_f32_16x16x64_bf16 v[68:71], v[24:27], v[96:103], v20
    s_cmp_gt_u32 s56, 320
    s_cbranch_scc1 L_xm4
L_md4:
    v_add_u32 v22, s79, v19
    ds_read_u16 v12, v22 offset:256
    ds_read_u16 v13, v22 offset:320
    ds_read_u16 v14, v22 offset:264
    ds_read_u16 v15, v22 offset:328
    ds_read_u16 v24, v22 offset:384
    ds_read_u16 v25, v22 offset:448
    ds_read_u16 v26, v22 offset:392
    ds_read_u16 v27, v22 offset:456
    s_cmp_le_u32 s52, 256
    s_cbranch_scc1 L_na5
    ds_read_u16 v28, v22 offset:512
    ds_read_u16 v29, v22 offset:576
    ds_read_u16 v30, v22 offset:520
    ds_read_u16 v31, v22 offset:584
L_na5:
    s_setprio 1
    s_cmp_le_u32 s53, 128
    s_cbranch_scc1 L_w5_0
    v_add_u32_dpp v17, v4, v16 row_newbcast:8 row_mask:0xf bank_mask:0xf
    buffer_load_dwordx4 v[72:75], v17, s[4:7], s84 offen
    v_add_u32_dpp v18, v4, v16 row_newbcast:9 row_mask:0xf bank_mask:0xf
    buffer_load_dwordx4 v[76:79], v18, s[4:7], s84 offen
    v_add_u32_dpp v17, v4, v16 row_newbcast:10 row_mask:0xf bank_mask:0xf
    buffer_load_dwordx4 v[80:83], v17, s[4:7], s84 offen
    v_add_u32_dpp v18, v4, v16 row_newbcast:11 row_mask:0xf bank_mask:0xf
    buffer_load_dwordx4 v[84:87], v18, s[4:7], s84 offen
    v_add_u32_dpp v17, v4, v16 row_newbcast:12 row_mask:0xf bank_mask:0xf
    buffer_load_dwordx4 v[88:91], v17, s[4:7], s84 offen
    s_cmp_le_u32 s53, 208
    s_cbranch_scc1 L_w5_5
    v_add_u32_dpp v18, v4, v16 row_newbcast:13 row_mask:0xf bank_mask:0xf
    buffer_load_dwordx4 v[92:95], v18, s[4:7], s84 offen
    s_cmp_le_u32 s53, 224
    s_cbranch_scc1 L_w5_6
    v_add_u32_dpp v17, v4, v16 row_newbcast:14 row_mask:0xf bank_mask:0xf
    buffer_load_dwordx4 v[96:99], v17, s[4:7], s84 offen
    s_cmp_le_u32 s53, 240
    s_cbranch_scc1 L_w5_7
    v_add_u32_dpp v18, v4, v16 row_newbcast:15 row_mask:0xf bank_mask:0xf
    buffer_load_dwordx4 v[100:103], v18, s[4:7], s84 offen
    s_cmp_le_u32 s53, 256
    s_cbranch_scc1 L_w5_8
    v_add_u32_dpp v17, v5, v16 row_newbcast:0 row_mask:0xf bank_mask:0xf
    buffer_load_dwordx4 v[104:107], v17, s[4:7], s84 offen
    s_cmp_le_u32 s53, 272
    s_cbranch_scc1 L_w5_9
    v_add_u32_dpp v18, v5, v16 row_newbcast:1 row_mask:0xf bank_mask:0xf
    buffer_load_dwordx4 v[108:111], v18, s[4:7], s84 offen
    s_cmp_le_u32 s53, 288
    s_cbranch_scc1 L_w5_10
    v_add_u32_dpp v17, v5, v16 row_newbcast:2 row_mask:0xf bank_mask:0xf
    buffer_load_dwordx4 v[112:115], v17, s[4:7], s84 offen
    s_cmp_le_u32 s53, 304
    s_cbranch_scc1 L_w5_11
    v_add_u32_dpp v18, v5, v16 row_newbcast:3 row_mask:0xf bank_mask:0xf
    buffer_load_dwordx4 v[116:119], v18, s[4:7], s84 offen
    s_branch L_w5_12
L_w5_5:
    s_waitcnt vmcnt(5)
L_w5_6:
    s_waitcnt vmcnt(6)
L_w5_7:
    s_waitcnt vmcnt(7)
L_w5_8:
    s_waitcnt vmcnt(8)
L_w5_9:
    s_waitcnt vmcnt(9)
L_w5_10:
    s_waitcnt vmcnt(10)
L_w5_11:
    s_waitcnt vmcnt(11)
L_w5_12:
    s_waitcnt vmcnt(12) lgkmcnt(0)
L_go5:
    v_swap_b32 v122, v128
    v_swap_b32 v123, v129
    v_swap_b32 v126, v132
    v_swap_b32 v127, v133
    v_swap_b32 v138, v144
    v_swap_b32 v139, v145
    v_swap_b32 v142, v148
    v_swap_b32 v143, v149
    v_smfmac_f32_16x16x64_bf16 v[32:35], v[12:15], v[120:127], v20
    v_smfmac_f32_16x16x64_bf16 v[36:39], v[12:15], v[128:135], v20
    v_smfmac_f32_16x16x64_bf16 v[32:35], v[24:27], v[136:143], v20
    v_smfmac_f32_16x16x64_bf16 v[36:39], v[24:27], v[144:151], v20
    s_cmp_le_u32 s52, 256
    s_cbranch_scc1 L_md5
    v_swap_b32 v154, v160
    v_swap_b32 v155, v161
    v_swap_b32 v158, v164
    v_swap_b32 v159, v165
    s_cmp_gt_u32 s52, 384
    s_nop 0
    v_smfmac_f32_16x16x64_bf16 v[32:35], v[28:31], v[152:159], v20
    v_smfmac_f32_16x16x64_bf16 v[36:39], v[28:31], v[160:167], v20
    s_cbranch_scc1 L_more5
L_md5:
    v_add_u32 v22, s80, v19
    ds_read_u16 v12, v22 offset:256
    ds_read_u16 v13, v22 offset:320
    ds_read_u16 v14, v22 offset:264
    ds_read_u16 v15, v22 offset:328
    ds_read_u16 v24, v22 offset:384
    ds_read_u16 v25, v22 offset:448
    ds_read_u16 v26, v22 offset:392
    ds_read_u16 v27, v22 offset:456
    s_cmp_le_u32 s53, 256
    s_cbranch_scc1 L_na6
    ds_read_u16 v28, v22 offset:512
    ds_read_u16 v29, v22 offset:576
    ds_read_u16 v30, v22 offset:520
    ds_read_u16 v31, v22 offset:584
L_na6:
    v_xor_b32 v23, s21, v21
    v_lshl_add_u32 v23, v23, 4, s16
    v_cvt_pk_bf16_f32 v32, v32, v33
    v_cvt_pk_bf16_f32 v33, v34, v35
    v_cvt_pk_bf16_f32 v34, v36, v37
    v_cvt_pk_bf16_f32 v35, v38, v39
    ds_write_b128 v23, v[32:35]
    v_mov_b32 v36, s26
    s_mov_b64 exec, 1
    ds_inc_u32 v36, v19
    s_mov_b64 exec, -1
    v_mov_b32 v37, 0
    v_mov_b32 v38, 0
    v_mov_b32 v39, 0
    v_mov_b32 v32, 0
    v_mov_b32 v33, 0
    v_mov_b32 v34, 0
    v_mov_b32 v35, 0
    v_mov_b32 v36, 0
    s_setprio 1
    s_cmp_le_u32 s54, 128
    s_cbranch_scc1 L_w6_0
    v_add_u32_dpp v17, v6, v16 row_newbcast:8 row_mask:0xf bank_mask:0xf
    buffer_load_dwordx4 v[120:123], v17, s[4:7], s84 offen
    v_add_u32_dpp v18, v6, v16 row_newbcast:9 row_mask:0xf bank_mask:0xf
    buffer_load_dwordx4 v[124:127], v18, s[4:7], s84 offen
    v_add_u32_dpp v17, v6, v16 row_newbcast:10 row_mask:0xf bank_mask:0xf
    buffer_load_dwordx4 v[128:131], v17, s[4:7], s84 offen
    v_add_u32_dpp v18, v6, v16 row_newbcast:11 row_mask:0xf bank_mask:0xf
    buffer_load_dwordx4 v[132:135], v18, s[4:7], s84 offen
    v_add_u32_dpp v17, v6, v16 row_newbcast:12 row_mask:0xf bank_mask:0xf
    buffer_load_dwordx4 v[136:139], v17, s[4:7], s84 offen
    s_cmp_le_u32 s54, 208
    s_cbranch_scc1 L_w6_5
    v_add_u32_dpp v18, v6, v16 row_newbcast:13 row_mask:0xf bank_mask:0xf
    buffer_load_dwordx4 v[140:143], v18, s[4:7], s84 offen
    s_cmp_le_u32 s54, 224
    s_cbranch_scc1 L_w6_6
    v_add_u32_dpp v17, v6, v16 row_newbcast:14 row_mask:0xf bank_mask:0xf
    buffer_load_dwordx4 v[144:147], v17, s[4:7], s84 offen
    s_cmp_le_u32 s54, 240
    s_cbranch_scc1 L_w6_7
    v_add_u32_dpp v18, v6, v16 row_newbcast:15 row_mask:0xf bank_mask:0xf
    buffer_load_dwordx4 v[148:151], v18, s[4:7], s84 offen
    s_cmp_le_u32 s54, 256
    s_cbranch_scc1 L_w6_8
    v_add_u32_dpp v17, v7, v16 row_newbcast:0 row_mask:0xf bank_mask:0xf
    buffer_load_dwordx4 v[152:155], v17, s[4:7], s84 offen
    s_cmp_le_u32 s54, 272
    s_cbranch_scc1 L_w6_9
    v_add_u32_dpp v18, v7, v16 row_newbcast:1 row_mask:0xf bank_mask:0xf
    buffer_load_dwordx4 v[156:159], v18, s[4:7], s84 offen
    s_cmp_le_u32 s54, 288
    s_cbranch_scc1 L_w6_10
    v_add_u32_dpp v17, v7, v16 row_newbcast:2 row_mask:0xf bank_mask:0xf
    buffer_load_dwordx4 v[160:163], v17, s[4:7], s84 offen
    s_cmp_le_u32 s54, 304
    s_cbranch_scc1 L_w6_11
    v_add_u32_dpp v18, v7, v16 row_newbcast:3 row_mask:0xf bank_mask:0xf
    buffer_load_dwordx4 v[164:167], v18, s[4:7], s84 offen
    s_branch L_w6_12
L_w6_5:
    s_waitcnt vmcnt(5)
L_w6_6:
    s_waitcnt vmcnt(6)
L_w6_7:
    s_waitcnt vmcnt(7)
L_w6_8:
    s_waitcnt vmcnt(8)
L_w6_9:
    s_waitcnt vmcnt(9)
L_w6_10:
    s_waitcnt vmcnt(10)
L_w6_11:
    s_waitcnt vmcnt(11)
L_w6_12:
    s_waitcnt vmcnt(12) lgkmcnt(0)
L_go6:
    v_swap_b32 v74, v80
    v_swap_b32 v75, v81
    v_swap_b32 v78, v84
    v_swap_b32 v79, v85
    v_swap_b32 v90, v96
    v_swap_b32 v91, v97
    v_swap_b32 v94, v100
    v_swap_b32 v95, v101
    v_smfmac_f32_16x16x64_bf16 v[40:43], v[12:15], v[72:79], v20
    v_smfmac_f32_16x16x64_bf16 v[44:47], v[12:15], v[80:87], v20
    v_smfmac_f32_16x16x64_bf16 v[40:43], v[24:27], v[88:95], v20
    v_smfmac_f32_16x16x64_bf16 v[44:47], v[24:27], v[96:103], v20
    s_cmp_le_u32 s53, 256
    s_cbranch_scc1 L_md6
    v_swap_b32 v106, v112
    v_swap_b32 v107, v113
    v_swap_b32 v110, v116
    v_swap_b32 v111, v117
    s_cmp_gt_u32 s53, 384
    s_nop 0
    v_smfmac_f32_16x16x64_bf16 v[40:43], v[28:31], v[104:111], v20
    v_smfmac_f32_16x16x64_bf16 v[44:47], v[28:31], v[112:119], v20
    s_cbranch_scc1 L_more6
L_md6:
    v_add_u32 v22, s81, v19
    ds_read_u16 v12, v22 offset:256
    ds_read_u16 v13, v22 offset:320
    ds_read_u16 v14, v22 offset:264
    ds_read_u16 v15, v22 offset:328
    ds_read_u16 v24, v22 offset:384
    ds_read_u16 v25, v22 offset:448
    ds_read_u16 v26, v22 offset:392
    ds_read_u16 v27, v22 offset:456
    s_cmp_le_u32 s54, 256
    s_cbranch_scc1 L_na7
    ds_read_u16 v28, v22 offset:512
    ds_read_u16 v29, v22 offset:576
    ds_read_u16 v30, v22 offset:520
    ds_read_u16 v31, v22 offset:584
L_na7:
    v_xor_b32 v23, s22, v21
    v_lshl_add_u32 v23, v23, 4, s17
    v_cvt_pk_bf16_f32 v40, v40, v41
    v_cvt_pk_bf16_f32 v41, v42, v43
    v_cvt_pk_bf16_f32 v42, v44, v45
    v_cvt_pk_bf16_f32 v43, v46, v47
    ds_write_b128 v23, v[40:43]
    v_mov_b32 v44, s27
    s_mov_b64 exec, 1
    ds_inc_u32 v44, v19
    s_mov_b64 exec, -1
    v_mov_b32 v45, 0
    v_mov_b32 v46, 0
    v_mov_b32 v47, 0
    v_mov_b32 v40, 0
    v_mov_b32 v41, 0
    v_mov_b32 v42, 0
    v_mov_b32 v43, 0
    v_mov_b32 v44, 0
    s_setprio 1
    s_cmp_ge_u32 s14, 4
    s_cbranch_scc1 L_pr7
    s_setprio 0
L_pr7:
    s_cmp_le_u32 s55, 128
    s_cbranch_scc1 L_w7_0
    v_add_u32_dpp v17, v8, v16 row_newbcast:8 row_mask:0xf bank_mask:0xf
    buffer_load_dwordx4 v[72:75], v17, s[4:7], s84 offen
    v_add_u32_dpp v18, v8, v16 row_newbcast:9 row_mask:0xf bank_mask:0xf
    buffer_load_dwordx4 v[76:79], v18, s[4:7], s84 offen
    v_add_u32_dpp v17, v8, v16 row_newbcast:10 row_mask:0xf bank_mask:0xf
    buffer_load_dwordx4 v[80:83], v17, s[4:7], s84 offen
    v_add_u32_dpp v18, v8, v16 row_newbcast:11 row_mask:0xf bank_mask:0xf
    buffer_load_dwordx4 v[84:87], v18, s[4:7], s84 offen
    v_add_u32_dpp v17, v8, v16 row_newbcast:12 row_mask:0xf bank_mask:0xf
    buffer_load_dwordx4 v[88:91], v17, s[4:7], s84 offen
    s_cmp_le_u32 s55, 208
    s_cbranch_scc1 L_w7_5
    v_add_u32_dpp v18, v8, v16 row_newbcast:13 row_mask:0xf bank_mask:0xf
    buffer_load_dwordx4 v[92:95], v18, s[4:7], s84 offen
    s_cmp_le_u32 s55, 224
    s_cbranch_scc1 L_w7_6
    v_add_u32_dpp v17, v8, v16 row_newbcast:14 row_mask:0xf bank_mask:0xf
    buffer_load_dwordx4 v[96:99], v17, s[4:7], s84 offen
    s_cmp_le_u32 s55, 240
    s_cbranch_scc1 L_w7_7
    v_add_u32_dpp v18, v8, v16 row_newbcast:15 row_mask:0xf bank_mask:0xf
    buffer_load_dwordx4 v[100:103], v18, s[4:7], s84 offen
    s_cmp_le_u32 s55, 256
    s_cbranch_scc1 L_w7_8
    v_add_u32_dpp v17, v9, v16 row_newbcast:0 row_mask:0xf bank_mask:0xf
    buffer_load_dwordx4 v[104:107], v17, s[4:7], s84 offen
    s_cmp_le_u32 s55, 272
    s_cbranch_scc1 L_w7_9
    v_add_u32_dpp v18, v9, v16 row_newbcast:1 row_mask:0xf bank_mask:0xf
    buffer_load_dwordx4 v[108:111], v18, s[4:7], s84 offen
    s_cmp_le_u32 s55, 288
    s_cbranch_scc1 L_w7_10
    v_add_u32_dpp v17, v9, v16 row_newbcast:2 row_mask:0xf bank_mask:0xf
    buffer_load_dwordx4 v[112:115], v17, s[4:7], s84 offen
    s_cmp_le_u32 s55, 304
    s_cbranch_scc1 L_w7_11
    v_add_u32_dpp v18, v9, v16 row_newbcast:3 row_mask:0xf bank_mask:0xf
    buffer_load_dwordx4 v[116:119], v18, s[4:7], s84 offen
    s_branch L_w7_12
L_w7_5:
    s_waitcnt vmcnt(5)
L_w7_6:
    s_waitcnt vmcnt(6)
L_w7_7:
    s_waitcnt vmcnt(7)
L_w7_8:
    s_waitcnt vmcnt(8)
L_w7_9:
    s_waitcnt vmcnt(9)
L_w7_10:
    s_waitcnt vmcnt(10)
L_w7_11:
    s_waitcnt vmcnt(11)
L_w7_12:
    s_waitcnt vmcnt(12) lgkmcnt(0)
L_go7:
    v_swap_b32 v122, v128
    v_swap_b32 v123, v129
    v_swap_b32 v126, v132
    v_swap_b32 v127, v133
    v_swap_b32 v138, v144
    v_swap_b32 v139, v145
    v_swap_b32 v142, v148
    v_swap_b32 v143, v149
    v_smfmac_f32_16x16x64_bf16 v[48:51], v[12:15], v[120:127], v20
    v_smfmac_f32_16x16x64_bf16 v[52:55], v[12:15], v[128:135], v20
    v_smfmac_f32_16x16x64_bf16 v[48:51], v[24:27], v[136:143], v20
    v_smfmac_f32_16x16x64_bf16 v[52:55], v[24:27], v[144:151], v20
    s_cmp_le_u32 s54, 256
    s_cbranch_scc1 L_md7
    v_swap_b32 v154, v160
    v_swap_b32 v155, v161
    v_swap_b32 v158, v164
    v_swap_b32 v159, v165
    s_cmp_gt_u32 s54, 384
    s_nop 0
    v_smfmac_f32_16x16x64_bf16 v[48:51], v[28:31], v[152:159], v20
    v_smfmac_f32_16x16x64_bf16 v[52:55], v[28:31], v[160:167], v20
    s_cbranch_scc1 L_more7
L_md7:
    v_add_u32 v22, s82, v19
    ds_read_u16 v12, v22 offset:256
    ds_read_u16 v13, v22 offset:320
    ds_read_u16 v14, v22 offset:264
    ds_read_u16 v15, v22 offset:328
    ds_read_u16 v24, v22 offset:384
    ds_read_u16 v25, v22 offset:448
    ds_read_u16 v26, v22 offset:392
    ds_read_u16 v27, v22 offset:456
    s_cmp_le_u32 s55, 256
    s_cbranch_scc1 L_na8
    ds_read_u16 v28, v22 offset:512
    ds_read_u16 v29, v22 offset:576
    ds_read_u16 v30, v22 offset:520
    ds_read_u16 v31, v22 offset:584
L_na8:
    v_xor_b32 v23, s23, v21
    v_lshl_add_u32 v23, v23, 4, s18
    v_cvt_pk_bf16_f32 v48, v48, v49
    v_cvt_pk_bf16_f32 v49, v50, v51
    v_cvt_pk_bf16_f32 v50, v52, v53
    v_cvt_pk_bf16_f32 v51, v54, v55
    ds_write_b128 v23, v[48:51]
    v_mov_b32 v52, s28
    s_mov_b64 exec, 1
    ds_inc_u32 v52, v19
    s_mov_b64 exec, -1
    v_mov_b32 v53, 0
    v_mov_b32 v54, 0
    v_mov_b32 v55, 0
    v_mov_b32 v48, 0
    v_mov_b32 v49, 0
    v_mov_b32 v50, 0
    v_mov_b32 v51, 0
    v_mov_b32 v52, 0
    s_setprio 0
    s_cmp_le_u32 s56, 128
    s_cbranch_scc1 L_w8_0
    v_add_u32_dpp v17, v10, v16 row_newbcast:8 row_mask:0xf bank_mask:0xf
    buffer_load_dwordx4 v[120:123], v17, s[4:7], s84 offen
    v_add_u32_dpp v18, v10, v16 row_newbcast:9 row_mask:0xf bank_mask:0xf
    buffer_load_dwordx4 v[124:127], v18, s[4:7], s84 offen
    v_add_u32_dpp v17, v10, v16 row_newbcast:10 row_mask:0xf bank_mask:0xf
    buffer_load_dwordx4 v[128:131], v17, s[4:7], s84 offen
    v_add_u32_dpp v18, v10, v16 row_newbcast:11 row_mask:0xf bank_mask:0xf
    buffer_load_dwordx4 v[132:135], v18, s[4:7], s84 offen
    v_add_u32_dpp v17, v10, v16 row_newbcast:12 row_mask:0xf bank_mask:0xf
    buffer_load_dwordx4 v[136:139], v17, s[4:7], s84 offen
    s_cmp_le_u32 s56, 208
    s_cbranch_scc1 L_w8_5
    v_add_u32_dpp v18, v10, v16 row_newbcast:13 row_mask:0xf bank_mask:0xf
    buffer_load_dwordx4 v[140:143], v18, s[4:7], s84 offen
    s_cmp_le_u32 s56, 224
    s_cbranch_scc1 L_w8_6
    v_add_u32_dpp v17, v10, v16 row_newbcast:14 row_mask:0xf bank_mask:0xf
    buffer_load_dwordx4 v[144:147], v17, s[4:7], s84 offen
    s_cmp_le_u32 s56, 240
    s_cbranch_scc1 L_w8_7
    v_add_u32_dpp v18, v10, v16 row_newbcast:15 row_mask:0xf bank_mask:0xf
    buffer_load_dwordx4 v[148:151], v18, s[4:7], s84 offen
    s_cmp_le_u32 s56, 256
    s_cbranch_scc1 L_w8_8
    v_add_u32_dpp v17, v11, v16 row_newbcast:0 row_mask:0xf bank_mask:0xf
    buffer_load_dwordx4 v[152:155], v17, s[4:7], s84 offen
    s_cmp_le_u32 s56, 272
    s_cbranch_scc1 L_w8_9
    v_add_u32_dpp v18, v11, v16 row_newbcast:1 row_mask:0xf bank_mask:0xf
    buffer_load_dwordx4 v[156:159], v18, s[4:7], s84 offen
    s_cmp_le_u32 s56, 288
    s_cbranch_scc1 L_w8_10
    v_add_u32_dpp v17, v11, v16 row_newbcast:2 row_mask:0xf bank_mask:0xf
    buffer_load_dwordx4 v[160:163], v17, s[4:7], s84 offen
    s_cmp_le_u32 s56, 304
    s_cbranch_scc1 L_w8_11
    v_add_u32_dpp v18, v11, v16 row_newbcast:3 row_mask:0xf bank_mask:0xf
    buffer_load_dwordx4 v[164:167], v18, s[4:7], s84 offen
    s_branch L_w8_12
L_w8_5:
    s_waitcnt vmcnt(5)
L_w8_6:
    s_waitcnt vmcnt(6)
L_w8_7:
    s_waitcnt vmcnt(7)
L_w8_8:
    s_waitcnt vmcnt(8)
L_w8_9:
    s_waitcnt vmcnt(9)
L_w8_10:
    s_waitcnt vmcnt(10)
L_w8_11:
    s_waitcnt vmcnt(11)
L_w8_12:
    s_waitcnt vmcnt(12) lgkmcnt(0)
L_go8:
    v_swap_b32 v74, v80
    v_swap_b32 v75, v81
    v_swap_b32 v78, v84
    v_swap_b32 v79, v85
    v_swap_b32 v90, v96
    v_swap_b32 v91, v97
    v_swap_b32 v94, v100
    v_swap_b32 v95, v101
    v_smfmac_f32_16x16x64_bf16 v[56:59], v[12:15], v[72:79], v20
    v_smfmac_f32_16x16x64_bf16 v[60:63], v[12:15], v[80:87], v20
    v_smfmac_f32_16x16x64_bf16 v[56:59], v[24:27], v[88:95], v20
    v_smfmac_f32_16x16x64_bf16 v[60:63], v[24:27], v[96:103], v20
    s_cmp_le_u32 s55, 256
    s_cbranch_scc1 L_md8
    v_swap_b32 v106, v112
    v_swap_b32 v107, v113
    v_swap_b32 v110, v116
    v_swap_b32 v111, v117
    s_cmp_gt_u32 s55, 384
    s_nop 0
    v_smfmac_f32_16x16x64_bf16 v[56:59], v[28:31], v[104:111], v20
    v_smfmac_f32_16x16x64_bf16 v[60:63], v[28:31], v[112:119], v20
    s_cbranch_scc1 L_more8
L_md8:
    v_add_u32 v22, s83, v19
    ds_read_u16 v12, v22 offset:256
    ds_read_u16 v13, v22 offset:320
    ds_read_u16 v14, v22 offset:264
    ds_read_u16 v15, v22 offset:328
    ds_read_u16 v24, v22 offset:384
    ds_read_u16 v25, v22 offset:448
    ds_read_u16 v26, v22 offset:392
    ds_read_u16 v27, v22 offset:456
    s_cmp_le_u32 s56, 256
    s_cbranch_scc1 L_na9
    ds_read_u16 v28, v22 offset:512
    ds_read_u16 v29, v22 offset:576
    ds_read_u16 v30, v22 offset:520
    ds_read_u16 v31, v22 offset:584
L_na9:
    v_xor_b32 v23, s24, v21
    v_lshl_add_u32 v23, v23, 4, s19
    v_cvt_pk_bf16_f32 v56, v56, v57
    v_cvt_pk_bf16_f32 v57, v58, v59
    v_cvt_pk_bf16_f32 v58, v60, v61
    v_cvt_pk_bf16_f32 v59, v62, v63
    ds_write_b128 v23, v[56:59]
    v_mov_b32 v60, s29
    s_mov_b64 exec, 1
    ds_inc_u32 v60, v19
    s_mov_b64 exec, -1
    v_mov_b32 v61, 0
    v_mov_b32 v62, 0
    v_mov_b32 v63, 0
    v_mov_b32 v56, 0
    v_mov_b32 v57, 0
    v_mov_b32 v58, 0
    v_mov_b32 v59, 0
    v_mov_b32 v60, 0
    s_setprio 3
    s_cmp_ge_u32 s14, 4
    s_cbranch_scc1 L_pr9
    s_setprio 2
L_pr9:
    s_cmp_eq_u32 s86, 0
    s_cbranch_scc1 L_w9_0
    v_add_u32_dpp v17, v2, v16 row_newbcast:0 row_mask:0xf bank_mask:0xf
    buffer_load_dwordx4 v[72:75], v17, s[4:7], s85 offen
    v_add_u32_dpp v18, v2, v16 row_newbcast:1 row_mask:0xf bank_mask:0xf
    buffer_load_dwordx4 v[76:79], v18, s[4:7], s85 offen
    v_add_u32_dpp v17, v2, v16 row_newbcast:2 row_mask:0xf bank_mask:0xf
    buffer_load_dwordx4 v[80:83], v17, s[4:7], s85 offen
    v_add_u32_dpp v18, v2, v16 row_newbcast:3 row_mask:0xf bank_mask:0xf
    buffer_load_dwordx4 v[84:87], v18, s[4:7], s85 offen
    v_add_u32_dpp v17, v2, v16 row_newbcast:4 row_mask:0xf bank_mask:0xf
    buffer_load_dwordx4 v[88:91], v17, s[4:7], s85 offen
    v_add_u32_dpp v18, v2, v16 row_newbcast:5 row_mask:0xf bank_mask:0xf
    buffer_load_dwordx4 v[92:95], v18, s[4:7], s85 offen
    v_add_u32_dpp v17, v2, v16 row_newbcast:6 row_mask:0xf bank_mask:0xf
    buffer_load_dwordx4 v[96:99], v17, s[4:7], s85 offen
    v_add_u32_dpp v18, v2, v16 row_newbcast:7 row_mask:0xf bank_mask:0xf
    buffer_load_dwordx4 v[100:103], v18, s[4:7], s85 offen
    s_cmp_gt_u32 s86, 320
    s_cbranch_scc1 L_xl9
    s_waitcnt vmcnt(8) lgkmcnt(0)
L_go9:
    v_swap_b32 v122, v128
    v_swap_b32 v123, v129
    v_swap_b32 v126, v132
    v_swap_b32 v127, v133
    v_swap_b32 v138, v144
    v_swap_b32 v139, v145
    v_swap_b32 v142, v148
    v_swap_b32 v143, v149
    v_smfmac_f32_16x16x64_bf16 v[64:67], v[12:15], v[120:127], v20
    v_smfmac_f32_16x16x64_bf16 v[68:71], v[12:15], v[128:135], v20
    v_smfmac_f32_16x16x64_bf16 v[64:67], v[24:27], v[136:143], v20
    v_smfmac_f32_16x16x64_bf16 v[68:71], v[24:27], v[144:151], v20
    s_cmp_le_u32 s56, 256
    s_cbranch_scc1 L_md9
    v_swap_b32 v154, v160
    v_swap_b32 v155, v161
    v_swap_b32 v158, v164
    v_swap_b32 v159, v165
    s_cmp_gt_u32 s56, 384
    s_nop 0
    v_smfmac_f32_16x16x64_bf16 v[64:67], v[28:31], v[152:159], v20
    v_smfmac_f32_16x16x64_bf16 v[68:71], v[28:31], v[160:167], v20
    s_cbranch_scc1 L_more9
L_md9:
    s_cmp_lg_u32 s84, 0
    s_nop 7
    v_xor_b32 v23, s25, v21
    v_lshl_add_u32 v23, v23, 4, s20
    v_cvt_pk_bf16_f32 v64, v64, v65
    v_cvt_pk_bf16_f32 v65, v66, v67
    v_cvt_pk_bf16_f32 v66, v68, v69
    v_cvt_pk_bf16_f32 v67, v70, v71
    ds_write_b128 v23, v[64:67]
    s_cbranch_scc1 L_tdone
    v_mov_b32 v68, s30
    s_mov_b64 exec, 1
    ds_inc_u32 v68, v19
    s_mov_b64 exec, -1
    v_mov_b32 v69, 0
    v_mov_b32 v70, 0
    v_mov_b32 v71, 0
    v_mov_b32 v64, 0
    v_mov_b32 v65, 0
    v_mov_b32 v66, 0
    v_mov_b32 v67, 0
    v_mov_b32 v68, 0
    s_add_u32 s16, s16, 256
    s_add_u32 s26, s26, 12
    s_add_u32 s17, s17, 256
    s_add_u32 s27, s27, 12
    s_add_u32 s18, s18, 256
    s_add_u32 s28, s28, 12
    s_add_u32 s19, s19, 256
    s_add_u32 s29, s29, 12
    s_add_u32 s20, s20, 256
    s_add_u32 s30, s30, 12
    s_mov_b32 s84, 256
    s_mov_b32 s86, 0
    s_branch L_hloop
L_tdone:
    s_waitcnt lgkmcnt(0)
    s_barrier
    s_cmp_eq_u32 s15, 0
    s_cbranch_scc1 L_gdone
    s_add_u32 s61, s61, 1
    s_cmp_lt_u32 s61, 64
    s_cselect_b32 s48, 0, 16
    s_cselect_b32 s61, s61, 0
    s_add_u32 s60, s60, s48
    s_cmp_ge_u32 s60, s64
    s_cbranch_scc1 L_gdone
    s_waitcnt lgkmcnt(0)
    s_barrier
    s_branch L_slow_load
L_gdone:
    s_endpgm
L_w0_0:
    s_waitcnt vmcnt(0) lgkmcnt(0)
    s_branch L_go0
L_w1_0:
    s_waitcnt vmcnt(0) lgkmcnt(0)
    s_branch L_go1
L_w2_0:
    s_waitcnt vmcnt(0) lgkmcnt(0)
    s_branch L_go2
L_w3_0:
    s_waitcnt vmcnt(0) lgkmcnt(0)
    s_branch L_go3
L_w4_0:
    s_waitcnt vmcnt(0) lgkmcnt(0)
    s_branch L_go4
L_w5_0:
    s_waitcnt vmcnt(0) lgkmcnt(0)
    s_branch L_go5
L_w6_0:
    s_waitcnt vmcnt(0) lgkmcnt(0)
    s_branch L_go6
L_w7_0:
    s_waitcnt vmcnt(0) lgkmcnt(0)
    s_branch L_go7
L_w8_0:
    s_waitcnt vmcnt(0) lgkmcnt(0)
    s_branch L_go8
L_w9_0:
    s_waitcnt vmcnt(0) lgkmcnt(0)
    s_branch L_go9
L_xa0:
    ds_read_u16 v28, v22 offset:640
    ds_read_u16 v29, v22 offset:704
    ds_read_u16 v30, v22 offset:648
    ds_read_u16 v31, v22 offset:712
    s_branch L_na0
L_xm0:
    v_swap_b32 v106, v112
    v_swap_b32 v107, v113
    v_swap_b32 v110, v116
    v_swap_b32 v111, v117
    s_nop 1
    v_smfmac_f32_16x16x64_bf16 v[32:35], v[28:31], v[104:111], v20
    v_smfmac_f32_16x16x64_bf16 v[36:39], v[28:31], v[112:119], v20
    s_branch L_md0
L_xl0:
    v_add_u32_dpp v17, v5, v16 row_newbcast:4 row_mask:0xf bank_mask:0xf
    buffer_load_dwordx4 v[152:155], v17, s[4:7], s84 offen
    v_add_u32_dpp v18, v5, v16 row_newbcast:5 row_mask:0xf bank_mask:0xf
    buffer_load_dwordx4 v[156:159], v18, s[4:7], s84 offen
    v_add_u32_dpp v17, v5, v16 row_newbcast:6 row_mask:0xf bank_mask:0xf
    buffer_load_dwordx4 v[160:163], v17, s[4:7], s84 offen
    v_add_u32_dpp v18, v5, v16 row_newbcast:7 row_mask:0xf bank_mask:0xf
    buffer_load_dwordx4 v[164:167], v18, s[4:7], s84 offen
    s_waitcnt vmcnt(12) lgkmcnt(0)
    s_branch L_go0
L_xa1:
    ds_read_u16 v28, v22 offset:640
    ds_read_u16 v29, v22 offset:704
    ds_read_u16 v30, v22 offset:648
    ds_read_u16 v31, v22 offset:712
    s_branch L_na1
L_xm1:
    v_swap_b32 v154, v160
    v_swap_b32 v155, v161
    v_swap_b32 v158, v164
    v_swap_b32 v159, v165
    s_nop 1
    v_smfmac_f32_16x16x64_bf16 v[40:43], v[28:31], v[152:159], v20
    v_smfmac_f32_16x16x64_bf16 v[44:47], v[28:31], v[160:167], v20
    s_branch L_md1
L_xl1:
    v_add_u32_dpp v17, v7, v16 row_newbcast:4 row_mask:0xf bank_mask:0xf
    buffer_load_dwordx4 v[104:107], v17, s[4:7], s84 offen
    v_add_u32_dpp v18, v7, v16 row_newbcast:5 row_mask:0xf bank_mask:0xf
    buffer_load_dwordx4 v[108:111], v18, s[4:7], s84 offen
    v_add_u32_dpp v17, v7, v16 row_newbcast:6 row_mask:0xf bank_mask:0xf
    buffer_load_dwordx4 v[112:115], v17, s[4:7], s84 offen
    v_add_u32_dpp v18, v7, v16 row_newbcast:7 row_mask:0xf bank_mask:0xf
    buffer_load_dwordx4 v[116:119], v18, s[4:7], s84 offen
    s_waitcnt vmcnt(12) lgkmcnt(0)
    s_branch L_go1
L_xa2:
    ds_read_u16 v28, v22 offset:640
    ds_read_u16 v29, v22 offset:704
    ds_read_u16 v30, v22 offset:648
    ds_read_u16 v31, v22 offset:712
    s_branch L_na2
L_xm2:
    v_swap_b32 v106, v112
    v_swap_b32 v107, v113
    v_swap_b32 v110, v116
    v_swap_b32 v111, v117
    s_nop 1
    v_smfmac_f32_16x16x64_bf16 v[48:51], v[28:31], v[104:111], v20
    v_smfmac_f32_16x16x64_bf16 v[52:55], v[28:31], v[112:119], v20
    s_branch L_md2
L_xl2:
    v_add_u32_dpp v17, v9, v16 row_newbcast:4 row_mask:0xf bank_mask:0xf
    buffer_load_dwordx4 v[152:155], v17, s[4:7], s84 offen
    v_add_u32_dpp v18, v9, v16 row_newbcast:5 row_mask:0xf bank_mask:0xf
    buffer_load_dwordx4 v[156:159], v18, s[4:7], s84 offen
    v_add_u32_dpp v17, v9, v16 row_newbcast:6 row_mask:0xf bank_mask:0xf
    buffer_load_dwordx4 v[160:163], v17, s[4:7], s84 offen
    v_add_u32_dpp v18, v9, v16 row_newbcast:7 row_mask:0xf bank_mask:0xf
    buffer_load_dwordx4 v[164:167], v18, s[4:7], s84 offen
    s_waitcnt vmcnt(12) lgkmcnt(0)
    s_branch L_go2
L_xa3:
    ds_read_u16 v28, v22 offset:640
    ds_read_u16 v29, v22 offset:704
    ds_read_u16 v30, v22 offset:648
    ds_read_u16 v31, v22 offset:712
    s_branch L_na3
L_xm3:
    v_swap_b32 v154, v160
    v_swap_b32 v155, v161
    v_swap_b32 v158, v164
    v_swap_b32 v159, v165
    s_nop 1
    v_smfmac_f32_16x16x64_bf16 v[56:59], v[28:31], v[152:159], v20
    v_smfmac_f32_16x16x64_bf16 v[60:63], v[28:31], v[160:167], v20
    s_branch L_md3
L_xl3:
    v_add_u32_dpp v17, v11, v16 row_newbcast:4 row_mask:0xf bank_mask:0xf
    buffer_load_dwordx4 v[104:107], v17, s[4:7], s84 offen
    v_add_u32_dpp v18, v11, v16 row_newbcast:5 row_mask:0xf bank_mask:0xf
    buffer_load_dwordx4 v[108:111], v18, s[4:7], s84 offen
    v_add_u32_dpp v17, v11, v16 row_newbcast:6 row_mask:0xf bank_mask:0xf
    buffer_load_dwordx4 v[112:115], v17, s[4:7], s84 offen
    v_add_u32_dpp v18, v11, v16 row_newbcast:7 row_mask:0xf bank_mask:0xf
    buffer_load_dwordx4 v[116:119], v18, s[4:7], s84 offen
    s_waitcnt vmcnt(12) lgkmcnt(0)
    s_branch L_go3
L_xa4:
    ds_read_u16 v28, v22 offset:640
    ds_read_u16 v29, v22 offset:704
    ds_read_u16 v30, v22 offset:648
    ds_read_u16 v31, v22 offset:712
    s_branch L_na4
L_xm4:
    v_swap_b32 v106, v112
    v_swap_b32 v107, v113
    v_swap_b32 v110, v116
    v_swap_b32 v111, v117
    s_nop 1
    v_smfmac_f32_16x16x64_bf16 v[64:67], v[28:31], v[104:111], v20
    v_smfmac_f32_16x16x64_bf16 v[68:71], v[28:31], v[112:119], v20
    s_branch L_md4
L_xl9:
    v_add_u32_dpp v17, v3, v16 row_newbcast:4 row_mask:0xf bank_mask:0xf
    buffer_load_dwordx4 v[104:107], v17, s[4:7], s85 offen
    v_add_u32_dpp v18, v3, v16 row_newbcast:5 row_mask:0xf bank_mask:0xf
    buffer_load_dwordx4 v[108:111], v18, s[4:7], s85 offen
    v_add_u32_dpp v17, v3, v16 row_newbcast:6 row_mask:0xf bank_mask:0xf
    buffer_load_dwordx4 v[112:115], v17, s[4:7], s85 offen
    v_add_u32_dpp v18, v3, v16 row_newbcast:7 row_mask:0xf bank_mask:0xf
    buffer_load_dwordx4 v[116:119], v18, s[4:7], s85 offen
    s_waitcnt vmcnt(12) lgkmcnt(0)
    s_branch L_go9
L_stages:
    s_cmp_eq_u32 s66, 0
    s_cbranch_scc1 L_wdone
    v_mov_b32 v80, 0
    v_mov_b32 v81, 0
    v_mov_b32 v82, 0
    v_mov_b32 v83, 0
    v_mov_b32 v84, 0
    v_mov_b32 v85, 0
    v_mov_b32 v86, 0
    v_mov_b32 v87, 0
    v_mov_b32 v88, 0
    v_mov_b32 v89, 0
    v_mov_b32 v90, 0
    v_mov_b32 v91, 0
    v_mov_b32 v92, 0
    v_mov_b32 v93, 0
    v_mov_b32 v94, 0
    v_mov_b32 v95, 0
    v_mov_b32 v96, 0
    v_mov_b32 v97, 0
    v_mov_b32 v98, 0
    v_mov_b32 v99, 0
    v_mov_b32 v100, 0
    v_mov_b32 v101, 0
    v_mov_b32 v102, 0
    v_mov_b32 v103, 0
    v_mov_b32 v104, 0
    v_mov_b32 v105, 0
    v_mov_b32 v106, 0
    v_mov_b32 v107, 0
    v_mov_b32 v108, 0
    v_mov_b32 v109, 0
    v_mov_b32 v110, 0
    v_mov_b32 v111, 0
    v_mov_b32 v112, 0
    v_mov_b32 v113, 0
    v_mov_b32 v114, 0
    v_mov_b32 v115, 0
    v_mov_b32 v116, 0
    v_mov_b32 v117, 0
    v_mov_b32 v118, 0
    v_mov_b32 v119, 0
    v_mov_b32 v120, 0
    v_mov_b32 v121, 0
    v_mov_b32 v122, 0
    v_mov_b32 v123, 0
    v_mov_b32 v124, 0
    v_mov_b32 v125, 0
    v_mov_b32 v126, 0
    v_mov_b32 v127, 0
    s_waitcnt lgkmcnt(0)
    v_lshlrev_b32 v24, 16, v32
    v_and_b32 v25, 0xffff0000, v32
    v_lshlrev_b32 v26, 16, v128
    v_and_b32 v27, 0xffff0000, v128
    v_mul_f32 v24, v24, v26
    v_mul_f32 v25, v25, v27
    v_cvt_pk_bf16_f32 v32, v24, v25
    v_lshlrev_b32 v24, 16, v33
    v_and_b32 v25, 0xffff0000, v33
    v_lshlrev_b32 v26, 16, v129
    v_and_b32 v27, 0xffff0000, v129
    v_mul_f32 v24, v24, v26
    v_mul_f32 v25, v25, v27
    v_cvt_pk_bf16_f32 v33, v24, v25
    v_lshlrev_b32 v24, 16, v34
    v_and_b32 v25, 0xffff0000, v34
    v_lshlrev_b32 v26, 16, v130
    v_and_b32 v27, 0xffff0000, v130
    v_mul_f32 v24, v24, v26
    v_mul_f32 v25, v25, v27
    v_cvt_pk_bf16_f32 v34, v24, v25
    v_lshlrev_b32 v24, 16, v35
    v_and_b32 v25, 0xffff0000, v35
    v_lshlrev_b32 v26, 16, v131
    v_and_b32 v27, 0xffff0000, v131
    v_mul_f32 v24, v24, v26
    v_mul_f32 v25, v25, v27
    v_cvt_pk_bf16_f32 v35, v24, v25
    v_lshlrev_b32 v24, 16, v36
    v_and_b32 v25, 0xffff0000, v36
    v_lshlrev_b32 v26, 16, v132
    v_and_b32 v27, 0xffff0000, v132
    v_mul_f32 v24, v24, v26
    v_mul_f32 v25, v25, v27
    v_cvt_pk_bf16_f32 v36, v24, v25
    v_lshlrev_b32 v24, 16, v37
    v_and_b32 v25, 0xffff0000, v37
    v_lshlrev_b32 v26, 16, v133
    v_and_b32 v27, 0xffff0000, v133
    v_mul_f32 v24, v24, v26
    v_mul_f32 v25, v25, v27
    v_cvt_pk_bf16_f32 v37, v24, v25
    v_lshlrev_b32 v24, 16, v38
    v_and_b32 v25, 0xffff0000, v38
    v_lshlrev_b32 v26, 16, v134
    v_and_b32 v27, 0xffff0000, v134
    v_mul_f32 v24, v24, v26
    v_mul_f32 v25, v25, v27
    v_cvt_pk_bf16_f32 v38, v24, v25
    v_lshlrev_b32 v24, 16, v39
    v_and_b32 v25, 0xffff0000, v39
    v_lshlrev_b32 v26, 16, v135
    v_and_b32 v27, 0xffff0000, v135
    v_mul_f32 v24, v24, v26
    v_mul_f32 v25, v25, v27
    v_cvt_pk_bf16_f32 v39, v24, v25
    v_lshlrev_b32 v24, 16, v40
    v_and_b32 v25, 0xffff0000, v40
    v_lshlrev_b32 v26, 16, v136
    v_and_b32 v27, 0xffff0000, v136
    v_mul_f32 v24, v24, v26
    v_mul_f32 v25, v25, v27
    v_cvt_pk_bf16_f32 v40, v24, v25
    v_lshlrev_b32 v24, 16, v41
    v_and_b32 v25, 0xffff0000, v41
    v_lshlrev_b32 v26, 16, v137
    v_and_b32 v27, 0xffff0000, v137
    v_mul_f32 v24, v24, v26
    v_mul_f32 v25, v25, v27
    v_cvt_pk_bf16_f32 v41, v24, v25
    v_lshlrev_b32 v24, 16, v42
    v_and_b32 v25, 0xffff0000, v42
    v_lshlrev_b32 v26, 16, v138
    v_and_b32 v27, 0xffff0000, v138
    v_mul_f32 v24, v24, v26
    v_mul_f32 v25, v25, v27
    v_cvt_pk_bf16_f32 v42, v24, v25
    v_lshlrev_b32 v24, 16, v43
    v_and_b32 v25, 0xffff0000, v43
    v_lshlrev_b32 v26, 16, v139
    v_and_b32 v27, 0xffff0000, v139
    v_mul_f32 v24, v24, v26
    v_mul_f32 v25, v25, v27
    v_cvt_pk_bf16_f32 v43, v24, v25
    v_lshlrev_b32 v24, 16, v44
    v_and_b32 v25, 0xffff0000, v44
    v_lshlrev_b32 v26, 16, v140
    v_and_b32 v27, 0xffff0000, v140
    v_mul_f32 v24, v24, v26
    v_mul_f32 v25, v25, v27
    v_cvt_pk_bf16_f32 v44, v24, v25
    v_lshlrev_b32 v24, 16, v45
    v_and_b32 v25, 0xffff0000, v45
    v_lshlrev_b32 v26, 16, v141
    v_and_b32 v27, 0xffff0000, v141
    v_mul_f32 v24, v24, v26
    v_mul_f32 v25, v25, v27
    v_cvt_pk_bf16_f32 v45, v24, v25
    v_lshlrev_b32 v24, 16, v46
    v_and_b32 v25, 0xffff0000, v46
    v_lshlrev_b32 v26, 16, v142
    v_and_b32 v27, 0xffff0000, v142
    v_mul_f32 v24, v24, v26
    v_mul_f32 v25, v25, v27
    v_cvt_pk_bf16_f32 v46, v24, v25
    v_lshlrev_b32 v24, 16, v47
    v_and_b32 v25, 0xffff0000, v47
    v_lshlrev_b32 v26, 16, v143
    v_and_b32 v27, 0xffff0000, v143
    v_mul_f32 v24, v24, v26
    v_mul_f32 v25, v25, v27
    v_cvt_pk_bf16_f32 v47, v24, v25
    v_lshlrev_b32 v24, 16, v48
    v_and_b32 v25, 0xffff0000, v48
    v_lshlrev_b32 v26, 16, v144
    v_and_b32 v27, 0xffff0000, v144
    v_mul_f32 v24, v24, v26
    v_mul_f32 v25, v25, v27
    v_cvt_pk_bf16_f32 v48, v24, v25
    v_lshlrev_b32 v24, 16, v49
    v_and_b32 v25, 0xffff0000, v49
    v_lshlrev_b32 v26, 16, v145
    v_and_b32 v27, 0xffff0000, v145
    v_mul_f32 v24, v24, v26
    v_mul_f32 v25, v25, v27
    v_cvt_pk_bf16_f32 v49, v24, v25
    v_lshlrev_b32 v24, 16, v50
    v_and_b32 v25, 0xffff0000, v50
    v_lshlrev_b32 v26, 16, v146
    v_and_b32 v27, 0xffff0000, v146
    v_mul_f32 v24, v24, v26
    v_mul_f32 v25, v25, v27
    v_cvt_pk_bf16_f32 v50, v24, v25
    v_lshlrev_b32 v24, 16, v51
    v_and_b32 v25, 0xffff0000, v51
    v_lshlrev_b32 v26, 16, v147
    v_and_b32 v27, 0xffff0000, v147
    v_mul_f32 v24, v24, v26
    v_mul_f32 v25, v25, v27
    v_cvt_pk_bf16_f32 v51, v24, v25
    v_lshlrev_b32 v24, 16, v52
    v_and_b32 v25, 0xffff0000, v52
    v_lshlrev_b32 v26, 16, v148
    v_and_b32 v27, 0xffff0000, v148
    v_mul_f32 v24, v24, v26
    v_mul_f32 v25, v25, v27
    v_cvt_pk_bf16_f32 v52, v24, v25
    v_lshlrev_b32 v24, 16, v53
    v_and_b32 v25, 0xffff0000, v53
    v_lshlrev_b32 v26, 16, v149
    v_and_b32 v27, 0xffff0000, v149
    v_mul_f32 v24, v24, v26
    v_mul_f32 v25, v25, v27
    v_cvt_pk_bf16_f32 v53, v24, v25
    v_lshlrev_b32 v24, 16, v54
    v_and_b32 v25, 0xffff0000, v54
    v_lshlrev_b32 v26, 16, v150
    v_and_b32 v27, 0xffff0000, v150
    v_mul_f32 v24, v24, v26
    v_mul_f32 v25, v25, v27
    v_cvt_pk_bf16_f32 v54, v24, v25
    v_lshlrev_b32 v24, 16, v55
    v_and_b32 v25, 0xffff0000, v55
    v_lshlrev_b32 v26, 16, v151
    v_and_b32 v27, 0xffff0000, v151
    v_mul_f32 v24, v24, v26
    v_mul_f32 v25, v25, v27
    v_cvt_pk_bf16_f32 v55, v24, v25
    v_lshlrev_b32 v24, 16, v56
    v_and_b32 v25, 0xffff0000, v56
    v_lshlrev_b32 v26, 16, v152
    v_and_b32 v27, 0xffff0000, v152
    v_mul_f32 v24, v24, v26
    v_mul_f32 v25, v25, v27
    v_cvt_pk_bf16_f32 v56, v24, v25
    v_lshlrev_b32 v24, 16, v57
    v_and_b32 v25, 0xffff0000, v57
    v_lshlrev_b32 v26, 16, v153
    v_and_b32 v27, 0xffff0000, v153
    v_mul_f32 v24, v24, v26
    v_mul_f32 v25, v25, v27
    v_cvt_pk_bf16_f32 v57, v24, v25
    v_lshlrev_b32 v24, 16, v58
    v_and_b32 v25, 0xffff0000, v58
    v_lshlrev_b32 v26, 16, v154
    v_and_b32 v27, 0xffff0000, v154
    v_mul_f32 v24, v24, v26
    v_mul_f32 v25, v25, v27
    v_cvt_pk_bf16_f32 v58, v24, v25
    v_lshlrev_b32 v24, 16, v59
    v_and_b32 v25, 0xffff0000, v59
    v_lshlrev_b32 v26, 16, v155
    v_and_b32 v27, 0xffff0000, v155
    v_mul_f32 v24, v24, v26
    v_mul_f32 v25, v25, v27
    v_cvt_pk_bf16_f32 v59, v24, v25
    v_lshlrev_b32 v24, 16, v60
    v_and_b32 v25, 0xffff0000, v60
    v_lshlrev_b32 v26, 16, v156
    v_and_b32 v27, 0xffff0000, v156
    v_mul_f32 v24, v24, v26
    v_mul_f32 v25, v25, v27
    v_cvt_pk_bf16_f32 v60, v24, v25
    v_lshlrev_b32 v24, 16, v61
    v_and_b32 v25, 0xffff0000, v61
    v_lshlrev_b32 v26, 16, v157
    v_and_b32 v27, 0xffff0000, v157
    v_mul_f32 v24, v24, v26
    v_mul_f32 v25, v25, v27
    v_cvt_pk_bf16_f32 v61, v24, v25
    v_lshlrev_b32 v24, 16, v62
    v_and_b32 v25, 0xffff0000, v62
    v_lshlrev_b32 v26, 16, v158
    v_and_b32 v27, 0xffff0000, v158
    v_mul_f32 v24, v24, v26
    v_mul_f32 v25, v25, v27
    v_cvt_pk_bf16_f32 v62, v24, v25
    v_lshlrev_b32 v24, 16, v63
    v_and_b32 v25, 0xffff0000, v63
    v_lshlrev_b32 v26, 16, v159
    v_and_b32 v27, 0xffff0000, v159
    v_mul_f32 v24, v24, v26
    v_mul_f32 v25, v25, v27
    v_cvt_pk_bf16_f32 v63, v24, v25
    v_lshlrev_b32 v24, 16, v64
    v_and_b32 v25, 0xffff0000, v64
    v_lshlrev_b32 v26, 16, v160
    v_and_b32 v27, 0xffff0000, v160
    v_mul_f32 v24, v24, v26
    v_mul_f32 v25, v25, v27
    v_cvt_pk_bf16_f32 v64, v24, v25
    v_lshlrev_b32 v24, 16, v65
    v_and_b32 v25, 0xffff0000, v65
    v_lshlrev_b32 v26, 16, v161
    v_and_b32 v27, 0xffff0000, v161
    v_mul_f32 v24, v24, v26
    v_mul_f32 v25, v25, v27
    v_cvt_pk_bf16_f32 v65, v24, v25
    v_lshlrev_b32 v24, 16, v66
    v_and_b32 v25, 0xffff0000, v66
    v_lshlrev_b32 v26, 16, v162
    v_and_b32 v27, 0xffff0000, v162
    v_mul_f32 v24, v24, v26
    v_mul_f32 v25, v25, v27
    v_cvt_pk_bf16_f32 v66, v24, v25
    v_lshlrev_b32 v24, 16, v67
    v_and_b32 v25, 0xffff0000, v67
    v_lshlrev_b32 v26, 16, v163
    v_and_b32 v27, 0xffff0000, v163
    v_mul_f32 v24, v24, v26
    v_mul_f32 v25, v25, v27
    v_cvt_pk_bf16_f32 v67, v24, v25
    v_lshlrev_b32 v24, 16, v68
    v_and_b32 v25, 0xffff0000, v68
    v_lshlrev_b32 v26, 16, v164
    v_and_b32 v27, 0xffff0000, v164
    v_mul_f32 v24, v24, v26
    v_mul_f32 v25, v25, v27
    v_cvt_pk_bf16_f32 v68, v24, v25
    v_lshlrev_b32 v24, 16, v69
    v_and_b32 v25, 0xffff0000, v69
    v_lshlrev_b32 v26, 16, v165
    v_and_b32 v27, 0xffff0000, v165
    v_mul_f32 v24, v24, v26
    v_mul_f32 v25, v25, v27
    v_cvt_pk_bf16_f32 v69, v24, v25
    v_lshlrev_b32 v24, 16, v70
    v_and_b32 v25, 0xffff0000, v70
    v_lshlrev_b32 v26, 16, v166
    v_and_b32 v27, 0xffff0000, v166
    v_mul_f32 v24, v24, v26
    v_mul_f32 v25, v25, v27
    v_cvt_pk_bf16_f32 v70, v24, v25
    v_lshlrev_b32 v24, 16, v71
    v_and_b32 v25, 0xffff0000, v71
    v_lshlrev_b32 v26, 16, v167
    v_and_b32 v27, 0xffff0000, v167
    v_mul_f32 v24, v24, v26
    v_mul_f32 v25, v25, v27
    v_cvt_pk_bf16_f32 v71, v24, v25
    v_xor_b32 v72, 0x80008000, v64
    v_xor_b32 v73, 0x80008000, v65
    v_xor_b32 v74, 0x80008000, v66
    v_xor_b32 v75, 0x80008000, v67
    v_xor_b32 v76, 0x80008000, v68
    v_xor_b32 v77, 0x80008000, v69
    v_xor_b32 v78, 0x80008000, v70
    v_xor_b32 v79, 0x80008000, v71
    s_mov_b32 s66, 0
L_wdone:
    s_cmp_lg_u32 s15, 0
    s_cbranch_scc1 L_nsp
    s_lshr_b32 s48, s2, 3
    s_lshl_b32 s48, s48, 2
    s_add_u32 s48, s48, s51
    s_min_u32 s48, s48, 124
    s_mul_i32 s48, s48, 20480
    s_add_u32 s48, s48, 2560256
    s_add_u32 s46, s4, s48
    s_addc_u32 s47, s5, 0
    s_and_b32 s48, s2, 7
    s_mul_i32 s48, s48, 2560
    s_add_u32 s48, s48, 0
    s_mov_b32 s49, 5
L_sp3:
    s_cmp_ge_u32 s48, 20480
    s_cselect_b32 s39, 20480, 0
    s_sub_u32 s48, s48, s39
    s_add_u32 s36, s46, s48
    s_addc_u32 s37, s47, 0
    s_waitcnt lgkmcnt(11)
    s_load_dword s87, s[36:37], 0
    s_load_dword s87, s[36:37], 64
    s_load_dword s87, s[36:37], 128
    s_load_dword s87, s[36:37], 192
    s_add_u32 s48, s48, 512
    s_sub_u32 s49, s49, 1
    s_cmp_lg_u32 s49, 0
    s_cbranch_scc1 L_sp3
    s_lshr_b32 s48, s2, 3
    s_lshl_b32 s48, s48, 2
    s_add_u32 s48, s48, s51
    s_min_u32 s48, s48, 124
    s_mul_i32 s48, s48, 20480
    s_add_u32 s48, s48, 256
    s_add_u32 s46, s4, s48
    s_addc_u32 s47, s5, 0
    s_and_b32 s48, s2, 7
    s_mul_i32 s48, s48, 2560
    s_add_u32 s48, s48, 0
    s_mov_b32 s49, 10
L_sp2:
    s_cmp_ge_u32 s48, 20480
    s_cselect_b32 s39, 20480, 0
    s_sub_u32 s48, s48, s39
    s_add_u32 s36, s46, s48
    s_addc_u32 s37, s47, 0
    s_waitcnt lgkmcnt(11)
    s_load_dword s87, s[36:37], 0
    s_load_dword s87, s[36:37], 64
    s_load_dword s87, s[36:37], 128
    s_load_dword s87, s[36:37], 192
    s_add_u32 s48, s48, 512
    s_sub_u32 s49, s49, 1
    s_cmp_lg_u32 s49, 0
    s_cbranch_scc1 L_sp2
L_nsp:
    s_or_b32 s48, s2, s51
    s_cmp_lg_u32 s48, 0
    s_cbranch_scc1 L_noepoch
    v_mov_b32 v8, 10485760
    v_mov_b32 v9, s73
    s_mov_b64 exec, 1
    global_store_dword v8, v9, s[8:9] sc1
    s_mov_b64 exec, -1
L_noepoch:
    s_waitcnt vmcnt(0)
    s_setprio 3
    s_mov_b32 s67, 1
    s_cmp_eq_u32 s15, 0
    s_cbranch_scc1 L_lastknown
    s_add_u32 s48, s60, 16
    s_cmp_ge_u32 s48, s64
    s_cselect_b32 s67, 1, 0
    s_cmp_eq_u32 s61, 63
    s_cselect_b32 s67, s67, 0
L_lastknown:
    s_mov_b32 s72, 0
L_poll_0_0:
    ds_read_b32 v8, v14 offset:320
    s_waitcnt lgkmcnt(0)
    v_readfirstlane_b32 s48, v8
    s_cmp_ge_u32 s48, 16
    s_cbranch_scc1 L_go_0_0
    s_sleep 4
    s_add_u32 s72, s72, 1
    s_cmp_lt_u32 s72, 0x40000
    s_cbranch_scc1 L_poll_0_0
    s_endpgm
L_go_0_0:
    ds_read_b128 v[128:131], v16 offset:0
    ds_read_b128 v[132:135], v17 offset:0
    ds_read_b128 v[136:139], v18 offset:0
    ds_read_b128 v[140:143], v19 offset:0
    ds_read_b128 v[144:147], v16 offset:512
    ds_read_b128 v[148:151], v17 offset:512
    ds_read_b128 v[152:155], v18 offset:512
    ds_read_b128 v[156:159], v19 offset:512
    s_waitcnt lgkmcnt(7)
    v_mfma_f32_16x16x32_bf16 v[80:83], v[32:35], v[128:131], v[80:83]
    ds_read_b128 v[128:131], v16 offset:1024
    s_waitcnt lgkmcnt(7)
    v_mfma_f32_16x16x32_bf16 v[80:83], v[36:39], v[132:135], v[80:83]
    ds_read_b128 v[132:135], v17 offset:1024
    s_waitcnt lgkmcnt(7)
    v_mfma_f32_16x16x32_bf16 v[84:87], v[56:59], v[136:139], v[84:87]
    ds_read_b128 v[136:139], v18 offset:1024
    s_waitcnt lgkmcnt(7)
    v_mfma_f32_16x16x32_bf16 v[84:87], v[60:63], v[140:143], v[84:87]
    ds_read_b128 v[140:143], v19 offset:1024
    s_waitcnt lgkmcnt(7)
    v_mfma_f32_16x16x32_bf16 v[84:87], v[48:51], v[144:147], v[84:87]
    ds_read_b128 v[144:147], v16 offset:1536
    s_waitcnt lgkmcnt(7)
    v_mfma_f32_16x16x32_bf16 v[84:87], v[52:55], v[148:151], v[84:87]
    ds_read_b128 v[148:151], v17 offset:1536
    s_waitcnt lgkmcnt(7)
    v_mfma_f32_16x16x32_bf16 v[80:83], v[40:43], v[152:155], v[80:83]
    ds_read_b128 v[152:155], v18 offset:1536
    s_waitcnt lgkmcnt(7)
    v_mfma_f32_16x16x32_bf16 v[80:83], v[44:47], v[156:159], v[80:83]
    ds_read_b128 v[156:159], v19 offset:1536
    s_waitcnt lgkmcnt(7)
    v_mfma_f32_16x16x32_bf16 v[88:91], v[48:51], v[128:131], v[88:91]
    s_waitcnt lgkmcnt(6)
    v_mfma_f32_16x16x32_bf16 v[88:91], v[52:55], v[132:135], v[88:91]
    s_waitcnt lgkmcnt(5)
    v_mfma_f32_16x16x32_bf16 v[92:95], v[72:75], v[136:139], v[92:95]
    s_waitcnt lgkmcnt(4)
    v_mfma_f32_16x16x32_bf16 v[92:95], v[76:79], v[140:143], v[92:95]
    s_waitcnt lgkmcnt(3)
    v_mfma_f32_16x16x32_bf16 v[92:95], v[48:51], v[144:147], v[92:95]
    s_waitcnt lgkmcnt(2)
    v_mfma_f32_16x16x32_bf16 v[92:95], v[52:55], v[148:151], v[92:95]
    s_waitcnt lgkmcnt(1)
    v_mfma_f32_16x16x32_bf16 v[88:91], v[64:67], v[152:155], v[88:91]
    s_waitcnt lgkmcnt(0)
    v_mfma_f32_16x16x32_bf16 v[88:91], v[68:71], v[156:159], v[88:91]
    s_mov_b32 s72, 0
L_poll_0_2:
    ds_read_b32 v8, v14 offset:328
    s_waitcnt lgkmcnt(0)
    v_readfirstlane_b32 s48, v8
    s_cmp_ge_u32 s48, 8
    s_cbranch_scc1 L_go_0_2
    s_sleep 4
    s_add_u32 s72, s72, 1
    s_cmp_lt_u32 s72, 0x40000
    s_cbranch_scc1 L_poll_0_2
    s_endpgm
L_go_0_2:
    ds_read_b128 v[128:131], v20 offset:0
    ds_read_b128 v[132:135], v21 offset:0
    ds_read_b128 v[136:139], v22 offset:0
    ds_read_b128 v[140:143], v23 offset:0
    ds_read_b128 v[144:147], v20 offset:512
    ds_read_b128 v[148:151], v21 offset:512
    ds_read_b128 v[152:155], v22 offset:512
    ds_read_b128 v[156:159], v23 offset:512
    s_waitcnt lgkmcnt(7)
    v_mfma_f32_16x16x32_bf16 v[112:115], v[32:35], v[128:131], v[112:115]
    ds_read_b128 v[128:131], v20 offset:1024
    s_waitcnt lgkmcnt(7)
    v_mfma_f32_16x16x32_bf16 v[112:115], v[36:39], v[132:135], v[112:115]
    ds_read_b128 v[132:135], v21 offset:1024
    s_waitcnt lgkmcnt(7)
    v_mfma_f32_16x16x32_bf16 v[116:119], v[56:59], v[136:139], v[116:119]
    ds_read_b128 v[136:139], v22 offset:1024
    s_waitcnt lgkmcnt(7)
    v_mfma_f32_16x16x32_bf16 v[116:119], v[60:63], v[140:143], v[116:119]
    ds_read_b128 v[140:143], v23 offset:1024
    s_waitcnt lgkmcnt(7)
    v_mfma_f32_16x16x32_bf16 v[116:119], v[48:51], v[144:147], v[116:119]
    ds_read_b128 v[144:147], v20 offset:1536
    s_waitcnt lgkmcnt(7)
    v_mfma_f32_16x16x32_bf16 v[116:119], v[52:55], v[148:151], v[116:119]
    ds_read_b128 v[148:151], v21 offset:1536
    s_waitcnt lgkmcnt(7)
    v_mfma_f32_16x16x32_bf16 v[112:115], v[40:43], v[152:155], v[112:115]
    ds_read_b128 v[152:155], v22 offset:1536
    s_waitcnt lgkmcnt(7)
    v_mfma_f32_16x16x32_bf16 v[112:115], v[44:47], v[156:159], v[112:115]
    ds_read_b128 v[156:159], v23 offset:1536
    s_waitcnt lgkmcnt(7)
    v_mfma_f32_16x16x32_bf16 v[120:123], v[48:51], v[128:131], v[120:123]
    s_waitcnt lgkmcnt(6)
    v_mfma_f32_16x16x32_bf16 v[120:123], v[52:55], v[132:135], v[120:123]
    s_waitcnt lgkmcnt(5)
    v_mfma_f32_16x16x32_bf16 v[124:127], v[72:75], v[136:139], v[124:127]
    s_waitcnt lgkmcnt(4)
    v_mfma_f32_16x16x32_bf16 v[124:127], v[76:79], v[140:143], v[124:127]
    s_waitcnt lgkmcnt(3)
    v_mfma_f32_16x16x32_bf16 v[124:127], v[48:51], v[144:147], v[124:127]
    s_waitcnt lgkmcnt(2)
    v_mfma_f32_16x16x32_bf16 v[124:127], v[52:55], v[148:151], v[124:127]
    s_waitcnt lgkmcnt(1)
    v_mfma_f32_16x16x32_bf16 v[120:123], v[64:67], v[152:155], v[120:123]
    s_waitcnt lgkmcnt(0)
    v_mfma_f32_16x16x32_bf16 v[120:123], v[68:71], v[156:159], v[120:123]
    s_mov_b32 s72, 0
L_poll_0_1:
    ds_read_b32 v8, v14 offset:324
    s_waitcnt lgkmcnt(0)
    v_readfirstlane_b32 s48, v8
    s_cmp_ge_u32 s48, 16
    s_cbranch_scc1 L_go_0_1
    s_sleep 4
    s_add_u32 s72, s72, 1
    s_cmp_lt_u32 s72, 0x40000
    s_cbranch_scc1 L_poll_0_1
    s_endpgm
L_go_0_1:
    ds_read_b128 v[128:131], v16 offset:32768
    ds_read_b128 v[132:135], v17 offset:32768
    ds_read_b128 v[136:139], v18 offset:32768
    ds_read_b128 v[140:143], v19 offset:32768
    ds_read_b128 v[144:147], v16 offset:33280
    ds_read_b128 v[148:151], v17 offset:33280
    ds_read_b128 v[152:155], v18 offset:33280
    ds_read_b128 v[156:159], v19 offset:33280
    s_waitcnt lgkmcnt(7)
    v_mfma_f32_16x16x32_bf16 v[96:99], v[32:35], v[128:131], v[96:99]
    ds_read_b128 v[128:131], v16 offset:33792
    s_waitcnt lgkmcnt(7)
    v_mfma_f32_16x16x32_bf16 v[96:99], v[36:39], v[132:135], v[96:99]
    ds_read_b128 v[132:135], v17 offset:33792
    s_waitcnt lgkmcnt(7)
    v_mfma_f32_16x16x32_bf16 v[100:103], v[56:59], v[136:139], v[100:103]
    ds_read_b128 v[136:139], v18 offset:33792
    s_waitcnt lgkmcnt(7)
    v_mfma_f32_16x16x32_bf16 v[100:103], v[60:63], v[140:143], v[100:103]
    ds_read_b128 v[140:143], v19 offset:33792
    s_waitcnt lgkmcnt(7)
    v_mfma_f32_16x16x32_bf16 v[100:103], v[48:51], v[144:147], v[100:103]
    ds_read_b128 v[144:147], v16 offset:34304
    s_waitcnt lgkmcnt(7)
    v_mfma_f32_16x16x32_bf16 v[100:103], v[52:55], v[148:151], v[100:103]
    ds_read_b128 v[148:151], v17 offset:34304
    s_waitcnt lgkmcnt(7)
    v_mfma_f32_16x16x32_bf16 v[96:99], v[40:43], v[152:155], v[96:99]
    ds_read_b128 v[152:155], v18 offset:34304
    s_waitcnt lgkmcnt(7)
    v_mfma_f32_16x16x32_bf16 v[96:99], v[44:47], v[156:159], v[96:99]
    ds_read_b128 v[156:159], v19 offset:34304
    s_waitcnt lgkmcnt(7)
    v_mfma_f32_16x16x32_bf16 v[104:107], v[48:51], v[128:131], v[104:107]
    s_waitcnt lgkmcnt(6)
    v_mfma_f32_16x16x32_bf16 v[104:107], v[52:55], v[132:135], v[104:107]
    s_waitcnt lgkmcnt(5)
    v_mfma_f32_16x16x32_bf16 v[108:111], v[72:75], v[136:139], v[108:111]
    s_waitcnt lgkmcnt(4)
    v_mfma_f32_16x16x32_bf16 v[108:111], v[76:79], v[140:143], v[108:111]
    s_waitcnt lgkmcnt(3)
    v_mfma_f32_16x16x32_bf16 v[108:111], v[48:51], v[144:147], v[108:111]
    s_waitcnt lgkmcnt(2)
    v_mfma_f32_16x16x32_bf16 v[108:111], v[52:55], v[148:151], v[108:111]
    s_waitcnt lgkmcnt(1)
    v_mfma_f32_16x16x32_bf16 v[104:107], v[64:67], v[152:155], v[104:107]
    s_waitcnt lgkmcnt(0)
    v_mfma_f32_16x16x32_bf16 v[104:107], v[68:71], v[156:159], v[104:107]
    s_mov_b32 s72, 0
L_poll_1_0:
    ds_read_b32 v8, v14 offset:332
    s_waitcnt lgkmcnt(0)
    v_readfirstlane_b32 s48, v8
    s_cmp_ge_u32 s48, 16
    s_cbranch_scc1 L_go_1_0
    s_sleep 4
    s_add_u32 s72, s72, 1
    s_cmp_lt_u32 s72, 0x40000
    s_cbranch_scc1 L_poll_1_0
    s_endpgm
L_go_1_0:
    ds_read_b128 v[128:131], v16 offset:256
    ds_read_b128 v[132:135], v17 offset:256
    ds_read_b128 v[136:139], v18 offset:256
    ds_read_b128 v[140:143], v19 offset:256
    ds_read_b128 v[144:147], v16 offset:768
    ds_read_b128 v[148:151], v17 offset:768
    ds_read_b128 v[152:155], v18 offset:768
    ds_read_b128 v[156:159], v19 offset:768
    s_waitcnt lgkmcnt(7)
    v_mfma_f32_16x16x32_bf16 v[88:91], v[56:59], v[128:131], v[88:91]
    ds_read_b128 v[128:131], v16 offset:1280
    s_waitcnt lgkmcnt(7)
    v_mfma_f32_16x16x32_bf16 v[88:91], v[60:63], v[132:135], v[88:91]
    ds_read_b128 v[132:135], v17 offset:1280
    s_waitcnt lgkmcnt(7)
    v_mfma_f32_16x16x32_bf16 v[92:95], v[56:59], v[136:139], v[92:95]
    ds_read_b128 v[136:139], v18 offset:1280
    s_waitcnt lgkmcnt(7)
    v_mfma_f32_16x16x32_bf16 v[92:95], v[60:63], v[140:143], v[92:95]
    ds_read_b128 v[140:143], v19 offset:1280
    s_waitcnt lgkmcnt(7)
    v_mfma_f32_16x16x32_bf16 v[92:95], v[64:67], v[144:147], v[92:95]
    ds_read_b128 v[144:147], v16 offset:1792
    s_waitcnt lgkmcnt(7)
    v_mfma_f32_16x16x32_bf16 v[92:95], v[68:71], v[148:151], v[92:95]
    ds_read_b128 v[148:151], v17 offset:1792
    s_waitcnt lgkmcnt(7)
    v_mfma_f32_16x16x32_bf16 v[88:91], v[72:75], v[152:155], v[88:91]
    ds_read_b128 v[152:155], v18 offset:1792
    s_waitcnt lgkmcnt(7)
    v_mfma_f32_16x16x32_bf16 v[88:91], v[76:79], v[156:159], v[88:91]
    ds_read_b128 v[156:159], v19 offset:1792
    s_waitcnt lgkmcnt(7)
    v_mfma_f32_16x16x32_bf16 v[80:83], v[40:43], v[128:131], v[80:83]
    s_waitcnt lgkmcnt(6)
    v_mfma_f32_16x16x32_bf16 v[80:83], v[44:47], v[132:135], v[80:83]
    s_waitcnt lgkmcnt(5)
    v_mfma_f32_16x16x32_bf16 v[84:87], v[64:67], v[136:139], v[84:87]
    s_waitcnt lgkmcnt(4)
    v_mfma_f32_16x16x32_bf16 v[84:87], v[68:71], v[140:143], v[84:87]
    s_waitcnt lgkmcnt(3)
    v_mfma_f32_16x16x32_bf16 v[84:87], v[72:75], v[144:147], v[84:87]
    s_waitcnt lgkmcnt(2)
    v_mfma_f32_16x16x32_bf16 v[84:87], v[76:79], v[148:151], v[84:87]
    s_waitcnt lgkmcnt(1)
    v_mfma_f32_16x16x32_bf16 v[80:83], v[40:43], v[152:155], v[80:83]
    s_waitcnt lgkmcnt(0)
    v_mfma_f32_16x16x32_bf16 v[80:83], v[44:47], v[156:159], v[80:83]
    s_cmp_eq_u32 s67, 0
    s_cbranch_scc1 L_nofin_0
    s_nop 5
    v_mul_f32 v8, s45, v80
    v_mul_f32 v9, s45, v81
    v_mul_f32 v10, s45, v82
    v_mul_f32 v11, s45, v83
    v_exp_f32 v8, v8
    v_exp_f32 v9, v9
    v_exp_f32 v10, v10
    v_exp_f32 v11, v11
    v_cvt_pk_bf16_f32 v24, v80, v81
    v_cvt_pk_bf16_f32 v25, v82, v83
    ds_write_b64 v5, v[24:25] offset:24576
    v_add_f32 v8, 1.0, v8
    v_add_f32 v9, 1.0, v9
    v_add_f32 v10, 1.0, v10
    v_add_f32 v11, 1.0, v11
    v_rcp_f32 v8, v8
    v_rcp_f32 v9, v9
    v_rcp_f32 v10, v10
    v_rcp_f32 v11, v11
    s_nop 0
    v_mul_f32 v84, v84, v8
    v_mul_f32 v85, v85, v9
    v_mul_f32 v86, v86, v10
    v_mul_f32 v87, v87, v11
    v_cvt_pk_bf16_f32 v26, v84, v85
    v_cvt_pk_bf16_f32 v27, v86, v87
    ds_write_b64 v5, v[26:27] offset:24704
    v_mul_f32 v88, v88, v8
    v_mul_f32 v89, v89, v9
    v_mul_f32 v90, v90, v10
    v_mul_f32 v91, v91, v11
    v_cvt_pk_bf16_f32 v28, v88, v89
    v_cvt_pk_bf16_f32 v29, v90, v91
    ds_write_b64 v5, v[28:29] offset:24832
    v_mul_f32 v92, v92, v8
    v_mul_f32 v93, v93, v9
    v_mul_f32 v94, v94, v10
    v_mul_f32 v95, v95, v11
    v_cvt_pk_bf16_f32 v30, v92, v93
    v_cvt_pk_bf16_f32 v31, v94, v95
    ds_write_b64 v5, v[30:31] offset:24960
    s_mov_b64 exec, 1
    ds_add_rtn_u32 v8, v14, v12 offset:352
    s_mov_b64 exec, -1
    s_waitcnt lgkmcnt(0)
    v_readfirstlane_b32 s48, v8
    s_cmp_lg_u32 s48, 3
    s_cbranch_scc1 L_nofin_0
    ds_read_b128 v[128:131], v6 offset:24576
    ds_read_b128 v[132:135], v6 offset:25632
    ds_read_b128 v[136:139], v6 offset:26688
    ds_read_b128 v[140:143], v6 offset:27744
    ds_read_b128 v[144:147], v6 offset:28800
    ds_read_b128 v[148:151], v6 offset:29856
    ds_read_b128 v[152:155], v6 offset:30912
    ds_read_b128 v[156:159], v6 offset:31968
    s_add_u32 s48, s44, 0
    s_waitcnt lgkmcnt(7)
    buffer_store_dwordx4 v[128:131], v7, s[40:43], s48 offen offset:0 sc1
    s_waitcnt lgkmcnt(6)
    buffer_store_dwordx4 v[132:135], v7, s[40:43], s48 offen offset:1024 sc1
    s_waitcnt lgkmcnt(5)
    buffer_store_dwordx4 v[136:139], v7, s[40:43], s48 offen offset:2048 sc1
    s_waitcnt lgkmcnt(4)
    buffer_store_dwordx4 v[140:143], v7, s[40:43], s48 offen offset:3072 sc1
    s_add_u32 s48, s44, 4096
    s_waitcnt lgkmcnt(3)
    buffer_store_dwordx4 v[144:147], v7, s[40:43], s48 offen offset:0 sc1
    s_waitcnt lgkmcnt(2)
    buffer_store_dwordx4 v[148:151], v7, s[40:43], s48 offen offset:1024 sc1
    s_waitcnt lgkmcnt(1)
    buffer_store_dwordx4 v[152:155], v7, s[40:43], s48 offen offset:2048 sc1
    s_waitcnt lgkmcnt(0)
    buffer_store_dwordx4 v[156:159], v7, s[40:43], s48 offen offset:3072 sc1
L_nofin_0:
    v_lshrrev_b32 v8, 5, v1
    v_lshlrev_b32 v8, 2, v8
    v_and_b32 v9, 0x1f0, v7
    ds_read_b32 v160, v8 offset:640
    ds_read_b32 v161, v8 offset:648
    ds_read_b32 v162, v8 offset:656
    ds_read_b32 v163, v8 offset:664
    s_waitcnt lgkmcnt(0)
    v_add_u32 v160, v9, v160
    v_add_u32 v161, v9, v161
    v_add_u32 v162, v9, v162
    v_add_u32 v163, v9, v163
    s_mov_b32 s72, 0
L_poll_1_2:
    ds_read_b32 v8, v14 offset:340
    s_waitcnt lgkmcnt(0)
    v_readfirstlane_b32 s48, v8
    s_cmp_ge_u32 s48, 8
    s_cbranch_scc1 L_go_1_2
    s_sleep 4
    s_add_u32 s72, s72, 1
    s_cmp_lt_u32 s72, 0x40000
    s_cbranch_scc1 L_poll_1_2
    s_endpgm
L_go_1_2:
    ds_read_b128 v[128:131], v20 offset:256
    ds_read_b128 v[132:135], v21 offset:256
    ds_read_b128 v[136:139], v22 offset:256
    ds_read_b128 v[140:143], v23 offset:256
    ds_read_b128 v[144:147], v20 offset:768
    ds_read_b128 v[148:151], v21 offset:768
    ds_read_b128 v[152:155], v22 offset:768
    ds_read_b128 v[156:159], v23 offset:768
    s_waitcnt lgkmcnt(7)
    v_mfma_f32_16x16x32_bf16 v[120:123], v[56:59], v[128:131], v[120:123]
    ds_read_b128 v[128:131], v20 offset:1280
    s_waitcnt lgkmcnt(7)
    v_mfma_f32_16x16x32_bf16 v[120:123], v[60:63], v[132:135], v[120:123]
    ds_read_b128 v[132:135], v21 offset:1280
    s_waitcnt lgkmcnt(7)
    v_mfma_f32_16x16x32_bf16 v[124:127], v[56:59], v[136:139], v[124:127]
    ds_read_b128 v[136:139], v22 offset:1280
    s_waitcnt lgkmcnt(7)
    v_mfma_f32_16x16x32_bf16 v[124:127], v[60:63], v[140:143], v[124:127]
    ds_read_b128 v[140:143], v23 offset:1280
    s_waitcnt lgkmcnt(7)
    v_mfma_f32_16x16x32_bf16 v[124:127], v[64:67], v[144:147], v[124:127]
    ds_read_b128 v[144:147], v20 offset:1792
    s_waitcnt lgkmcnt(7)
    v_mfma_f32_16x16x32_bf16 v[124:127], v[68:71], v[148:151], v[124:127]
    ds_read_b128 v[148:151], v21 offset:1792
    s_waitcnt lgkmcnt(7)
    v_mfma_f32_16x16x32_bf16 v[120:123], v[72:75], v[152:155], v[120:123]
    ds_read_b128 v[152:155], v22 offset:1792
    s_waitcnt lgkmcnt(7)
    v_mfma_f32_16x16x32_bf16 v[120:123], v[76:79], v[156:159], v[120:123]
    ds_read_b128 v[156:159], v23 offset:1792
    s_waitcnt lgkmcnt(7)
    v_mfma_f32_16x16x32_bf16 v[112:115], v[40:43], v[128:131], v[112:115]
    s_waitcnt lgkmcnt(6)
    v_mfma_f32_16x16x32_bf16 v[112:115], v[44:47], v[132:135], v[112:115]
    s_waitcnt lgkmcnt(5)
    v_mfma_f32_16x16x32_bf16 v[116:119], v[64:67], v[136:139], v[116:119]
    s_waitcnt lgkmcnt(4)
    v_mfma_f32_16x16x32_bf16 v[116:119], v[68:71], v[140:143], v[116:119]
    s_waitcnt lgkmcnt(3)
    v_mfma_f32_16x16x32_bf16 v[116:119], v[72:75], v[144:147], v[116:119]
    s_waitcnt lgkmcnt(2)
    v_mfma_f32_16x16x32_bf16 v[116:119], v[76:79], v[148:151], v[116:119]
    s_waitcnt lgkmcnt(1)
    v_mfma_f32_16x16x32_bf16 v[112:115], v[40:43], v[152:155], v[112:115]
    s_waitcnt lgkmcnt(0)
    v_mfma_f32_16x16x32_bf16 v[112:115], v[44:47], v[156:159], v[112:115]
    s_cmp_eq_u32 s67, 0
    s_cbranch_scc1 L_nofin_2
    s_nop 5
    v_mul_f32 v8, s45, v112
    v_mul_f32 v9, s45, v113
    v_mul_f32 v10, s45, v114
    v_mul_f32 v11, s45, v115
    v_exp_f32 v8, v8
    v_exp_f32 v9, v9
    v_exp_f32 v10, v10
    v_exp_f32 v11, v11
    v_cvt_pk_bf16_f32 v24, v112, v113
    v_cvt_pk_bf16_f32 v25, v114, v115
    ds_write_b64 v5, v[24:25] offset:0
    v_add_f32 v8, 1.0, v8
    v_add_f32 v9, 1.0, v9
    v_add_f32 v10, 1.0, v10
    v_add_f32 v11, 1.0, v11
    v_rcp_f32 v8, v8
    v_rcp_f32 v9, v9
    v_rcp_f32 v10, v10
    v_rcp_f32 v11, v11
    s_nop 0
    v_mul_f32 v116, v116, v8
    v_mul_f32 v117, v117, v9
    v_mul_f32 v118, v118, v10
    v_mul_f32 v119, v119, v11
    v_cvt_pk_bf16_f32 v26, v116, v117
    v_cvt_pk_bf16_f32 v27, v118, v119
    ds_write_b64 v5, v[26:27] offset:128
    v_mul_f32 v120, v120, v8
    v_mul_f32 v121, v121, v9
    v_mul_f32 v122, v122, v10
    v_mul_f32 v123, v123, v11
    v_cvt_pk_bf16_f32 v28, v120, v121
    v_cvt_pk_bf16_f32 v29, v122, v123
    ds_write_b64 v5, v[28:29] offset:256
    v_mul_f32 v124, v124, v8
    v_mul_f32 v125, v125, v9
    v_mul_f32 v126, v126, v10
    v_mul_f32 v127, v127, v11
    v_cvt_pk_bf16_f32 v30, v124, v125
    v_cvt_pk_bf16_f32 v31, v126, v127
    ds_write_b64 v5, v[30:31] offset:384
    s_mov_b64 exec, 1
    ds_add_rtn_u32 v8, v14, v12 offset:360
    s_mov_b64 exec, -1
    s_waitcnt lgkmcnt(0)
    v_readfirstlane_b32 s48, v8
    s_cmp_lg_u32 s48, 3
    s_cbranch_scc1 L_nofin_2
    ds_read_b128 v[128:131], v6 offset:0
    ds_read_b128 v[132:135], v6 offset:1056
    ds_read_b128 v[136:139], v6 offset:2112
    ds_read_b128 v[140:143], v6 offset:3168
    s_waitcnt lgkmcnt(3)
    buffer_store_dwordx4 v[128:131], v160, s[40:43], s44 offen sc1
    s_waitcnt lgkmcnt(2)
    buffer_store_dwordx4 v[132:135], v161, s[40:43], s44 offen sc1
    s_waitcnt lgkmcnt(1)
    buffer_store_dwordx4 v[136:139], v162, s[40:43], s44 offen sc1
    s_waitcnt lgkmcnt(0)
    buffer_store_dwordx4 v[140:143], v163, s[40:43], s44 offen sc1
L_nofin_2:
    v_lshrrev_b32 v8, 5, v1
    s_lshl_b32 s48, s51, 4
    v_lshl_add_u32 v8, v8, 2, s48
    v_and_b32 v9, 0x1f0, v7
    ds_read2_b32 v[160:161], v8 offset0:144 offset1:146
    s_mul_i32 s48, s51, 2112
    v_add_u32 v13, s48, v6
    s_waitcnt lgkmcnt(0)
    v_add_u32 v160, v9, v160
    v_add_u32 v161, v9, v161
    s_barrier
    ds_read_b128 v[128:131], v16 offset:34048
    ds_read_b128 v[132:135], v17 offset:34048
    ds_read_b128 v[136:139], v18 offset:34560
    ds_read_b128 v[140:143], v19 offset:34560
    ds_read_b128 v[144:147], v18 offset:34048
    ds_read_b128 v[148:151], v19 offset:34048
    ds_read_b128 v[152:155], v16 offset:34560
    ds_read_b128 v[156:159], v17 offset:34560
    s_waitcnt lgkmcnt(7)
    v_mfma_f32_16x16x32_bf16 v[96:99], v[40:43], v[128:131], v[96:99]
    ds_read_b128 v[128:131], v16 offset:33024
    s_waitcnt lgkmcnt(7)
    v_mfma_f32_16x16x32_bf16 v[96:99], v[44:47], v[132:135], v[96:99]
    ds_read_b128 v[132:135], v17 offset:33024
    s_waitcnt lgkmcnt(7)
    v_mfma_f32_16x16x32_bf16 v[96:99], v[40:43], v[136:139], v[96:99]
    ds_read_b128 v[136:139], v18 offset:33536
    s_waitcnt lgkmcnt(7)
    v_mfma_f32_16x16x32_bf16 v[96:99], v[44:47], v[140:143], v[96:99]
    ds_read_b128 v[140:143], v19 offset:33536
    s_waitcnt lgkmcnt(7)
    v_mfma_f32_16x16x32_bf16 v[100:103], v[64:67], v[144:147], v[100:103]
    ds_read_b128 v[144:147], v18 offset:33024
    s_waitcnt lgkmcnt(7)
    v_mfma_f32_16x16x32_bf16 v[100:103], v[68:71], v[148:151], v[100:103]
    ds_read_b128 v[148:151], v19 offset:33024
    s_waitcnt lgkmcnt(7)
    v_mfma_f32_16x16x32_bf16 v[100:103], v[72:75], v[152:155], v[100:103]
    v_mul_f32 v8, s45, v96
    v_mul_f32 v9, s45, v97
    v_mul_f32 v10, s45, v98
    v_mul_f32 v11, s45, v99
    ds_read_b128 v[152:155], v16 offset:33536
    s_waitcnt lgkmcnt(7)
    v_mfma_f32_16x16x32_bf16 v[100:103], v[76:79], v[156:159], v[100:103]
    v_exp_f32 v8, v8
    v_exp_f32 v9, v9
    ds_read_b128 v[156:159], v17 offset:33536
    s_waitcnt lgkmcnt(7)
    v_mfma_f32_16x16x32_bf16 v[104:107], v[56:59], v[128:131], v[104:107]
    v_exp_f32 v10, v10
    v_exp_f32 v11, v11
    s_waitcnt lgkmcnt(6)
    v_mfma_f32_16x16x32_bf16 v[104:107], v[60:63], v[132:135], v[104:107]
    v_add_f32 v8, 1.0, v8
    v_add_f32 v9, 1.0, v9
    v_add_f32 v10, 1.0, v10
    v_add_f32 v11, 1.0, v11
    s_waitcnt lgkmcnt(5)
    v_mfma_f32_16x16x32_bf16 v[104:107], v[72:75], v[136:139], v[104:107]
    v_rcp_f32 v8, v8
    v_rcp_f32 v9, v9
    s_waitcnt lgkmcnt(4)
    v_mfma_f32_16x16x32_bf16 v[104:107], v[76:79], v[140:143], v[104:107]
    v_rcp_f32 v10, v10
    v_rcp_f32 v11, v11
    s_waitcnt lgkmcnt(3)
    v_mfma_f32_16x16x32_bf16 v[108:111], v[56:59], v[144:147], v[108:111]
    v_cvt_pk_bf16_f32 v24, v96, v97
    v_cvt_pk_bf16_f32 v25, v98, v99
    ds_write_b64 v5, v[24:25] offset:33024
    s_waitcnt lgkmcnt(3)
    v_mfma_f32_16x16x32_bf16 v[108:111], v[60:63], v[148:151], v[108:111]
    v_mul_f32 v28, v100, v8
    v_mul_f32 v29, v101, v9
    v_mul_f32 v30, v102, v10
    v_mul_f32 v31, v103, v11
    v_cvt_pk_bf16_f32 v26, v28, v29
    v_cvt_pk_bf16_f32 v27, v30, v31
    ds_write_b64 v5, v[26:27] offset:33152
    s_waitcnt lgkmcnt(3)
    v_mfma_f32_16x16x32_bf16 v[108:111], v[64:67], v[152:155], v[108:111]
    s_waitcnt lgkmcnt(2)
    v_mfma_f32_16x16x32_bf16 v[108:111], v[68:71], v[156:159], v[108:111]
    v_mul_f32 v28, v104, v8
    v_mul_f32 v29, v105, v9
    v_mul_f32 v30, v106, v10
    v_mul_f32 v31, v107, v11
    v_cvt_pk_bf16_f32 v24, v28, v29
    v_cvt_pk_bf16_f32 v25, v30, v31
    ds_write_b64 v5, v[24:25] offset:33280
    s_cmp_eq_u32 s67, 0
    v_mul_f32 v28, v108, v8
    v_mul_f32 v29, v109, v9
    v_mul_f32 v30, v110, v10
    v_mul_f32 v31, v111, v11
    v_cvt_pk_bf16_f32 v26, v28, v29
    v_cvt_pk_bf16_f32 v27, v30, v31
    ds_write_b64 v5, v[26:27] offset:33408
    s_cbranch_scc1 L_nofin_1
    s_waitcnt lgkmcnt(0)
    s_barrier
    ds_read_b128 v[128:131], v13 offset:33024
    ds_read_b128 v[132:135], v13 offset:34080
    s_waitcnt lgkmcnt(1)
    buffer_store_dwordx4 v[128:131], v160, s[40:43], s44 offen sc1
    s_waitcnt lgkmcnt(0)
    buffer_store_dwordx4 v[132:135], v161, s[40:43], s44 offen sc1
L_nofin_1:
    s_cmp_eq_u32 s15, 0
    s_cbranch_scc1 L_final
    s_add_u32 s61, s61, 1
    s_cmp_lt_u32 s61, 64
    s_cselect_b32 s48, 0, 16
    s_cselect_b32 s61, s61, 0
    s_add_u32 s60, s60, s48
    s_cmp_ge_u32 s60, s64
    s_cbranch_scc1 L_final
    s_waitcnt lgkmcnt(0)
    s_barrier
    s_branch L_gnext
L_final:
L_end:
    s_endpgm
L_cold:
L_retry:
    s_waitcnt vmcnt(0)
    s_add_u32 s57, s57, 1
    s_cmp_le_u32 s57, 1
    s_cbranch_scc1 L_again
    s_branch L_flagwait
L_long:
    s_cmp_eq_u32 s66, 0
    s_cbranch_scc1 L_flagwait
    v_mov_b32 v9, 0
    s_mov_b64 exec, vcc
    ds_max_u32 v9, v4 offset:368
    s_mov_b64 exec, -1
    s_branch L_load
L_flagwait:
    s_mov_b32 s58, 0
    s_mov_b32 exec_lo, 0x00ff00ff
    s_mov_b32 exec_hi, 0x00ff00ff
L_fw:
    global_load_dwordx2 v[12:13], v69, s[8:9] sc1
    s_waitcnt vmcnt(0)
    v_not_b32 v13, v13
    v_cmp_ne_u32 vcc, s73, v12
    v_cmp_ne_u32 s[48:49], s73, v13
    s_or_b64 vcc, vcc, s[48:49]
    s_cbranch_scc0 L_fok
    s_sleep 2
    s_mov_b64 exec, vcc
    s_add_u32 s58, s58, 1
    s_cmp_lt_u32 s58, 0x80000
    s_cbranch_scc1 L_fw
    s_endpgm
L_fok:
    s_mov_b32 s66, -1
L_again:
    s_mov_b64 exec, -1
    v_mov_b32 v7, s73
    v_mov_b32 v72, 0
    v_mov_b32 v73, 0
    v_mov_b32 v74, 0
    v_mov_b32 v75, 0
    v_mov_b32 v76, 0
    v_mov_b32 v77, 0
    v_mov_b32 v78, 0
    v_mov_b32 v79, 0
    v_mov_b32 v80, 0
    v_mov_b32 v81, 0
    v_mov_b32 v82, 0
    v_mov_b32 v83, 0
    v_mov_b32 v84, 0
    v_mov_b32 v85, 0
    v_mov_b32 v86, 0
    v_mov_b32 v87, 0
    v_mov_b32 v88, 0
    v_mov_b32 v89, 0
    v_mov_b32 v90, 0
    v_mov_b32 v91, 0
    v_mov_b32 v92, 0
    v_mov_b32 v93, 0
    v_mov_b32 v94, 0
    v_mov_b32 v95, 0
    v_mov_b32 v96, 0
    v_mov_b32 v97, 0
    v_mov_b32 v98, 0
    v_mov_b32 v99, 0
    v_mov_b32 v100, 0
    v_mov_b32 v101, 0
    v_mov_b32 v102, 0
    v_mov_b32 v103, 0
    s_mov_b32 exec_lo, 0x00ff00ff
    s_mov_b32 exec_hi, 0x00ff00ff
    global_load_dwordx2 v[6:7], v30, s[8:9] sc1
    s_branch L_tpoll
L_more5:
    s_cmp_le_u32 s52, 384
    s_cbranch_scc1 L_mi5
    v_add_u32_dpp v17, v3, v16 row_newbcast:8 row_mask:0xf bank_mask:0xf
    buffer_load_dwordx4 v[120:123], v17, s[4:7], s84 offen
    s_cmp_le_u32 s52, 400
    s_cbranch_scc1 L_mi5
    v_add_u32_dpp v18, v3, v16 row_newbcast:9 row_mask:0xf bank_mask:0xf
    buffer_load_dwordx4 v[124:127], v18, s[4:7], s84 offen
    s_cmp_le_u32 s52, 416
    s_cbranch_scc1 L_mi5
    v_add_u32_dpp v17, v3, v16 row_newbcast:10 row_mask:0xf bank_mask:0xf
    buffer_load_dwordx4 v[128:131], v17, s[4:7], s84 offen
    s_cmp_le_u32 s52, 432
    s_cbranch_scc1 L_mi5
    v_add_u32_dpp v18, v3, v16 row_newbcast:11 row_mask:0xf bank_mask:0xf
    buffer_load_dwordx4 v[132:135], v18, s[4:7], s84 offen
    s_cmp_le_u32 s52, 448
    s_cbranch_scc1 L_mi5
    v_add_u32_dpp v17, v3, v16 row_newbcast:12 row_mask:0xf bank_mask:0xf
    buffer_load_dwordx4 v[136:139], v17, s[4:7], s84 offen
    s_cmp_le_u32 s52, 464
    s_cbranch_scc1 L_mi5
    v_add_u32_dpp v18, v3, v16 row_newbcast:13 row_mask:0xf bank_mask:0xf
    buffer_load_dwordx4 v[140:143], v18, s[4:7], s84 offen
    s_cmp_le_u32 s52, 480
    s_cbranch_scc1 L_mi5
    v_add_u32_dpp v17, v3, v16 row_newbcast:14 row_mask:0xf bank_mask:0xf
    buffer_load_dwordx4 v[144:147], v17, s[4:7], s84 offen
    s_cmp_le_u32 s52, 496
    s_cbranch_scc1 L_mi5
    v_add_u32_dpp v18, v3, v16 row_newbcast:15 row_mask:0xf bank_mask:0xf
    buffer_load_dwordx4 v[148:151], v18, s[4:7], s84 offen
L_mi5:
    s_cmp_le_u32 s52, 384
    s_cbranch_scc1 L_mx5
    ds_read_u16 v12, v22 offset:768
    ds_read_u16 v13, v22 offset:832
    ds_read_u16 v14, v22 offset:776
    ds_read_u16 v15, v22 offset:840
    s_waitcnt vmcnt(0) lgkmcnt(0)
    v_swap_b32 v122, v128
    v_swap_b32 v123, v129
    v_swap_b32 v126, v132
    v_swap_b32 v127, v133
    s_nop 1
    v_smfmac_f32_16x16x64_bf16 v[32:35], v[12:15], v[120:127], v20
    v_smfmac_f32_16x16x64_bf16 v[36:39], v[12:15], v[128:135], v20
    s_cmp_le_u32 s52, 448
    s_cbranch_scc1 L_mx5
    ds_read_u16 v12, v22 offset:896
    ds_read_u16 v13, v22 offset:960
    ds_read_u16 v14, v22 offset:904
    ds_read_u16 v15, v22 offset:968
    s_waitcnt vmcnt(0) lgkmcnt(0)
    v_swap_b32 v138, v144
    v_swap_b32 v139, v145
    v_swap_b32 v142, v148
    v_swap_b32 v143, v149
    s_nop 1
    v_smfmac_f32_16x16x64_bf16 v[32:35], v[12:15], v[136:143], v20
    v_smfmac_f32_16x16x64_bf16 v[36:39], v[12:15], v[144:151], v20
L_mx5:
    s_branch L_md5
L_more6:
    s_cmp_le_u32 s53, 384
    s_cbranch_scc1 L_mi6
    v_add_u32_dpp v17, v5, v16 row_newbcast:8 row_mask:0xf bank_mask:0xf
    buffer_load_dwordx4 v[72:75], v17, s[4:7], s84 offen
    s_cmp_le_u32 s53, 400
    s_cbranch_scc1 L_mi6
    v_add_u32_dpp v18, v5, v16 row_newbcast:9 row_mask:0xf bank_mask:0xf
    buffer_load_dwordx4 v[76:79], v18, s[4:7], s84 offen
    s_cmp_le_u32 s53, 416
    s_cbranch_scc1 L_mi6
    v_add_u32_dpp v17, v5, v16 row_newbcast:10 row_mask:0xf bank_mask:0xf
    buffer_load_dwordx4 v[80:83], v17, s[4:7], s84 offen
    s_cmp_le_u32 s53, 432
    s_cbranch_scc1 L_mi6
    v_add_u32_dpp v18, v5, v16 row_newbcast:11 row_mask:0xf bank_mask:0xf
    buffer_load_dwordx4 v[84:87], v18, s[4:7], s84 offen
    s_cmp_le_u32 s53, 448
    s_cbranch_scc1 L_mi6
    v_add_u32_dpp v17, v5, v16 row_newbcast:12 row_mask:0xf bank_mask:0xf
    buffer_load_dwordx4 v[88:91], v17, s[4:7], s84 offen
    s_cmp_le_u32 s53, 464
    s_cbranch_scc1 L_mi6
    v_add_u32_dpp v18, v5, v16 row_newbcast:13 row_mask:0xf bank_mask:0xf
    buffer_load_dwordx4 v[92:95], v18, s[4:7], s84 offen
    s_cmp_le_u32 s53, 480
    s_cbranch_scc1 L_mi6
    v_add_u32_dpp v17, v5, v16 row_newbcast:14 row_mask:0xf bank_mask:0xf
    buffer_load_dwordx4 v[96:99], v17, s[4:7], s84 offen
    s_cmp_le_u32 s53, 496
    s_cbranch_scc1 L_mi6
    v_add_u32_dpp v18, v5, v16 row_newbcast:15 row_mask:0xf bank_mask:0xf
    buffer_load_dwordx4 v[100:103], v18, s[4:7], s84 offen
L_mi6:
    s_cmp_le_u32 s53, 384
    s_cbranch_scc1 L_mx6
    ds_read_u16 v12, v22 offset:768
    ds_read_u16 v13, v22 offset:832
    ds_read_u16 v14, v22 offset:776
    ds_read_u16 v15, v22 offset:840
    s_waitcnt vmcnt(0) lgkmcnt(0)
    v_swap_b32 v74, v80
    v_swap_b32 v75, v81
    v_swap_b32 v78, v84
    v_swap_b32 v79, v85
    s_nop 1
    v_smfmac_f32_16x16x64_bf16 v[40:43], v[12:15], v[72:79], v20
    v_smfmac_f32_16x16x64_bf16 v[44:47], v[12:15], v[80:87], v20
    s_cmp_le_u32 s53, 448
    s_cbranch_scc1 L_mx6
    ds_read_u16 v12, v22 offset:896
    ds_read_u16 v13, v22 offset:960
    ds_read_u16 v14, v22 offset:904
    ds_read_u16 v15, v22 offset:968
    s_waitcnt vmcnt(0) lgkmcnt(0)
    v_swap_b32 v90, v96
    v_swap_b32 v91, v97
    v_swap_b32 v94, v100
    v_swap_b32 v95, v101
    s_nop 1
    v_smfmac_f32_16x16x64_bf16 v[40:43], v[12:15], v[88:95], v20
    v_smfmac_f32_16x16x64_bf16 v[44:47], v[12:15], v[96:103], v20
L_mx6:
    s_branch L_md6
L_more7:
    s_cmp_le_u32 s54, 384
    s_cbranch_scc1 L_mi7
    v_add_u32_dpp v17, v7, v16 row_newbcast:8 row_mask:0xf bank_mask:0xf
    buffer_load_dwordx4 v[120:123], v17, s[4:7], s84 offen
    s_cmp_le_u32 s54, 400
    s_cbranch_scc1 L_mi7
    v_add_u32_dpp v18, v7, v16 row_newbcast:9 row_mask:0xf bank_mask:0xf
    buffer_load_dwordx4 v[124:127], v18, s[4:7], s84 offen
    s_cmp_le_u32 s54, 416
    s_cbranch_scc1 L_mi7
    v_add_u32_dpp v17, v7, v16 row_newbcast:10 row_mask:0xf bank_mask:0xf
    buffer_load_dwordx4 v[128:131], v17, s[4:7], s84 offen
    s_cmp_le_u32 s54, 432
    s_cbranch_scc1 L_mi7
    v_add_u32_dpp v18, v7, v16 row_newbcast:11 row_mask:0xf bank_mask:0xf
    buffer_load_dwordx4 v[132:135], v18, s[4:7], s84 offen
    s_cmp_le_u32 s54, 448
    s_cbranch_scc1 L_mi7
    v_add_u32_dpp v17, v7, v16 row_newbcast:12 row_mask:0xf bank_mask:0xf
    buffer_load_dwordx4 v[136:139], v17, s[4:7], s84 offen
    s_cmp_le_u32 s54, 464
    s_cbranch_scc1 L_mi7
    v_add_u32_dpp v18, v7, v16 row_newbcast:13 row_mask:0xf bank_mask:0xf
    buffer_load_dwordx4 v[140:143], v18, s[4:7], s84 offen
    s_cmp_le_u32 s54, 480
    s_cbranch_scc1 L_mi7
    v_add_u32_dpp v17, v7, v16 row_newbcast:14 row_mask:0xf bank_mask:0xf
    buffer_load_dwordx4 v[144:147], v17, s[4:7], s84 offen
    s_cmp_le_u32 s54, 496
    s_cbranch_scc1 L_mi7
    v_add_u32_dpp v18, v7, v16 row_newbcast:15 row_mask:0xf bank_mask:0xf
    buffer_load_dwordx4 v[148:151], v18, s[4:7], s84 offen
L_mi7:
    s_cmp_le_u32 s54, 384
    s_cbranch_scc1 L_mx7
    ds_read_u16 v12, v22 offset:768
    ds_read_u16 v13, v22 offset:832
    ds_read_u16 v14, v22 offset:776
    ds_read_u16 v15, v22 offset:840
    s_waitcnt vmcnt(0) lgkmcnt(0)
    v_swap_b32 v122, v128
    v_swap_b32 v123, v129
    v_swap_b32 v126, v132
    v_swap_b32 v127, v133
    s_nop 1
    v_smfmac_f32_16x16x64_bf16 v[48:51], v[12:15], v[120:127], v20
    v_smfmac_f32_16x16x64_bf16 v[52:55], v[12:15], v[128:135], v20
    s_cmp_le_u32 s54, 448
    s_cbranch_scc1 L_mx7
    ds_read_u16 v12, v22 offset:896
    ds_read_u16 v13, v22 offset:960
    ds_read_u16 v14, v22 offset:904
    ds_read_u16 v15, v22 offset:968
    s_waitcnt vmcnt(0) lgkmcnt(0)
    v_swap_b32 v138, v144
    v_swap_b32 v139, v145
    v_swap_b32 v142, v148
    v_swap_b32 v143, v149
    s_nop 1
    v_smfmac_f32_16x16x64_bf16 v[48:51], v[12:15], v[136:143], v20
    v_smfmac_f32_16x16x64_bf16 v[52:55], v[12:15], v[144:151], v20
L_mx7:
    s_branch L_md7
L_more8:
    s_cmp_le_u32 s55, 384
    s_cbranch_scc1 L_mi8
    v_add_u32_dpp v17, v9, v16 row_newbcast:8 row_mask:0xf bank_mask:0xf
    buffer_load_dwordx4 v[72:75], v17, s[4:7], s84 offen
    s_cmp_le_u32 s55, 400
    s_cbranch_scc1 L_mi8
    v_add_u32_dpp v18, v9, v16 row_newbcast:9 row_mask:0xf bank_mask:0xf
    buffer_load_dwordx4 v[76:79], v18, s[4:7], s84 offen
    s_cmp_le_u32 s55, 416
    s_cbranch_scc1 L_mi8
    v_add_u32_dpp v17, v9, v16 row_newbcast:10 row_mask:0xf bank_mask:0xf
    buffer_load_dwordx4 v[80:83], v17, s[4:7], s84 offen
    s_cmp_le_u32 s55, 432
    s_cbranch_scc1 L_mi8
    v_add_u32_dpp v18, v9, v16 row_newbcast:11 row_mask:0xf bank_mask:0xf
    buffer_load_dwordx4 v[84:87], v18, s[4:7], s84 offen
    s_cmp_le_u32 s55, 448
    s_cbranch_scc1 L_mi8
    v_add_u32_dpp v17, v9, v16 row_newbcast:12 row_mask:0xf bank_mask:0xf
    buffer_load_dwordx4 v[88:91], v17, s[4:7], s84 offen
    s_cmp_le_u32 s55, 464
    s_cbranch_scc1 L_mi8
    v_add_u32_dpp v18, v9, v16 row_newbcast:13 row_mask:0xf bank_mask:0xf
    buffer_load_dwordx4 v[92:95], v18, s[4:7], s84 offen
    s_cmp_le_u32 s55, 480
    s_cbranch_scc1 L_mi8
    v_add_u32_dpp v17, v9, v16 row_newbcast:14 row_mask:0xf bank_mask:0xf
    buffer_load_dwordx4 v[96:99], v17, s[4:7], s84 offen
    s_cmp_le_u32 s55, 496
    s_cbranch_scc1 L_mi8
    v_add_u32_dpp v18, v9, v16 row_newbcast:15 row_mask:0xf bank_mask:0xf
    buffer_load_dwordx4 v[100:103], v18, s[4:7], s84 offen
L_mi8:
    s_cmp_le_u32 s55, 384
    s_cbranch_scc1 L_mx8
    ds_read_u16 v12, v22 offset:768
    ds_read_u16 v13, v22 offset:832
    ds_read_u16 v14, v22 offset:776
    ds_read_u16 v15, v22 offset:840
    s_waitcnt vmcnt(0) lgkmcnt(0)
    v_swap_b32 v74, v80
    v_swap_b32 v75, v81
    v_swap_b32 v78, v84
    v_swap_b32 v79, v85
    s_nop 1
    v_smfmac_f32_16x16x64_bf16 v[56:59], v[12:15], v[72:79], v20
    v_smfmac_f32_16x16x64_bf16 v[60:63], v[12:15], v[80:87], v20
    s_cmp_le_u32 s55, 448
    s_cbranch_scc1 L_mx8
    ds_read_u16 v12, v22 offset:896
    ds_read_u16 v13, v22 offset:960
    ds_read_u16 v14, v22 offset:904
    ds_read_u16 v15, v22 offset:968
    s_waitcnt vmcnt(0) lgkmcnt(0)
    v_swap_b32 v90, v96
    v_swap_b32 v91, v97
    v_swap_b32 v94, v100
    v_swap_b32 v95, v101
    s_nop 1
    v_smfmac_f32_16x16x64_bf16 v[56:59], v[12:15], v[88:95], v20
    v_smfmac_f32_16x16x64_bf16 v[60:63], v[12:15], v[96:103], v20
L_mx8:
    s_branch L_md8
L_more9:
    s_cmp_le_u32 s56, 384
    s_cbranch_scc1 L_mi9
    v_add_u32_dpp v17, v11, v16 row_newbcast:8 row_mask:0xf bank_mask:0xf
    buffer_load_dwordx4 v[120:123], v17, s[4:7], s84 offen
    s_cmp_le_u32 s56, 400
    s_cbranch_scc1 L_mi9
    v_add_u32_dpp v18, v11, v16 row_newbcast:9 row_mask:0xf bank_mask:0xf
    buffer_load_dwordx4 v[124:127], v18, s[4:7], s84 offen
    s_cmp_le_u32 s56, 416
    s_cbranch_scc1 L_mi9
    v_add_u32_dpp v17, v11, v16 row_newbcast:10 row_mask:0xf bank_mask:0xf
    buffer_load_dwordx4 v[128:131], v17, s[4:7], s84 offen
    s_cmp_le_u32 s56, 432
    s_cbranch_scc1 L_mi9
    v_add_u32_dpp v18, v11, v16 row_newbcast:11 row_mask:0xf bank_mask:0xf
    buffer_load_dwordx4 v[132:135], v18, s[4:7], s84 offen
    s_cmp_le_u32 s56, 448
    s_cbranch_scc1 L_mi9
    v_add_u32_dpp v17, v11, v16 row_newbcast:12 row_mask:0xf bank_mask:0xf
    buffer_load_dwordx4 v[136:139], v17, s[4:7], s84 offen
    s_cmp_le_u32 s56, 464
    s_cbranch_scc1 L_mi9
    v_add_u32_dpp v18, v11, v16 row_newbcast:13 row_mask:0xf bank_mask:0xf
    buffer_load_dwordx4 v[140:143], v18, s[4:7], s84 offen
    s_cmp_le_u32 s56, 480
    s_cbranch_scc1 L_mi9
    v_add_u32_dpp v17, v11, v16 row_newbcast:14 row_mask:0xf bank_mask:0xf
    buffer_load_dwordx4 v[144:147], v17, s[4:7], s84 offen
    s_cmp_le_u32 s56, 496
    s_cbranch_scc1 L_mi9
    v_add_u32_dpp v18, v11, v16 row_newbcast:15 row_mask:0xf bank_mask:0xf
    buffer_load_dwordx4 v[148:151], v18, s[4:7], s84 offen
L_mi9:
    s_cmp_le_u32 s56, 384
    s_cbranch_scc1 L_mx9
    ds_read_u16 v12, v22 offset:768
    ds_read_u16 v13, v22 offset:832
    ds_read_u16 v14, v22 offset:776
    ds_read_u16 v15, v22 offset:840
    s_waitcnt vmcnt(0) lgkmcnt(0)
    v_swap_b32 v122, v128
    v_swap_b32 v123, v129
    v_swap_b32 v126, v132
    v_swap_b32 v127, v133
    s_nop 1
    v_smfmac_f32_16x16x64_bf16 v[64:67], v[12:15], v[120:127], v20
    v_smfmac_f32_16x16x64_bf16 v[68:71], v[12:15], v[128:135], v20
    s_cmp_le_u32 s56, 448
    s_cbranch_scc1 L_mx9
    ds_read_u16 v12, v22 offset:896
    ds_read_u16 v13, v22 offset:960
    ds_read_u16 v14, v22 offset:904
    ds_read_u16 v15, v22 offset:968
    s_waitcnt vmcnt(0) lgkmcnt(0)
    v_swap_b32 v138, v144
    v_swap_b32 v139, v145
    v_swap_b32 v142, v148
    v_swap_b32 v143, v149
    s_nop 1
    v_smfmac_f32_16x16x64_bf16 v[64:67], v[12:15], v[136:143], v20
    v_smfmac_f32_16x16x64_bf16 v[68:71], v[12:15], v[144:151], v20
L_mx9:
    s_branch L_md9
L_slow_load:
    s_barrier
    v_and_b32 v2, 15, v0
    v_lshrrev_b32 v3, 4, v1
    v_mov_b32 v23, 4
    v_mov_b32 v17, 512
    v_lshlrev_b32 v18, 2, v3
    v_lshl_add_u32 v18, v2, 4, v18
    s_cmp_ge_u32 s14, 1
    s_cbranch_scc1 L_placed
    s_lshl_b32 s48, s61, 2
    v_add_u32 v6, s48, v3
    v_lshrrev_b32 v8, 6, v6
    v_lshlrev_b32 v8, 5, v8
    v_and_or_b32 v8, v6, 31, v8
    v_mul_u32_u24 v8, 4224, v8
    v_bfe_u32 v7, v6, 5, 1
    v_lshl_add_u32 v7, v7, 6, v8
    v_add_u32 v7, s75, v7
    global_load_dword v8, v7, s[8:9] sc1
    v_mul_u32_u24 v6, 30848, v6
    v_add_u32 v10, s60, v2
    v_mov_b32 v25, 25344
    s_waitcnt vmcnt(0)
    v_bfe_u32 v9, v8, 12, 12
    v_and_b32 v8, 0xfff, v8
    v_add_u32 v8, v8, v10
    v_mul_u32_u24 v8, 12, v8
    v_add_u32 v35, v8, v6
    v_cmp_lt_u32 vcc, v10, v9
    s_and_b64 exec, exec, vcc
    s_cbranch_execz L_placed
    global_load_dwordx3 v[32:34], v35, s[8:9] sc1
    s_waitcnt vmcnt(0)
    v_bfe_u32 v15, v34, 16, 1
    v_mad_u32_u16 v35, v34, v23, s50 op_sel:[1,0,0,0]
    v_lshl_add_u32 v15, v15, 3, -4
    ds_add_rtn_u32 v35, v35, v15
    s_waitcnt lgkmcnt(0)
    v_med3_u32 v35, v35, s59, v25
    v_lshlrev_b32 v8, 1, v35
    ds_write_b32 v35, v34
    ds_write_b64 v8, v[32:33] offset:23552
    s_branch L_placed
L_gnext:
    v_mov_b32 v8, 0
    v_mov_b32 v9, 0
    v_mov_b32 v10, 0
    v_mov_b32 v11, 0
    s_lshl_b32 s48, s51, 10
    v_lshl_add_u32 v13, v1, 4, s48
    v_add_u32 v15, 0x8000, v13
    ds_write_b128 v13, v[8:11] offset:1024
    ds_write_b128 v13, v[8:11] offset:5120
    ds_write_b128 v13, v[8:11] offset:9216
    ds_write_b128 v13, v[8:11] offset:13312
    ds_write_b128 v13, v[8:11] offset:17408
    ds_write_b128 v13, v[8:11] offset:21504
    ds_write_b128 v13, v[8:11] offset:25600
    ds_write_b128 v13, v[8:11] offset:29696
    ds_write_b128 v15, v[8:11] offset:1024
    ds_write_b128 v15, v[8:11] offset:5120
    ds_write_b128 v15, v[8:11] offset:9216
    ds_write_b128 v15, v[8:11] offset:13312
    ds_write_b128 v15, v[8:11] offset:17408
    ds_write_b128 v15, v[8:11] offset:21504
    ds_write_b128 v15, v[8:11] offset:25600
    ds_write_b128 v15, v[8:11] offset:29696
    ds_write_b128 v15, v[8:11] offset:33792
    ds_write_b128 v15, v[8:11] offset:37888
    s_cmp_lg_u32 s51, 0
    s_cbranch_scc1 L_gn2
    v_mul_u32_u24 v9, 1216, v1
    v_add_u32 v8, 1292, v9
    v_add_u32 v10, 1900, v9
    v_add_u32 v11, 1904, v9
    v_add_u32 v9, 1296, v9
    v_cmp_gt_u32 vcc, 20, v1
    v_lshlrev_b32 v13, 4, v1
    s_nop 0
    v_cndmask_b32 v8, 0, v8, vcc
    v_cndmask_b32 v9, 0, v9, vcc
    v_cndmask_b32 v10, 0, v10, vcc
    v_cndmask_b32 v11, 0, v11, vcc
    ds_write_b128 v13, v[8:11]
L_gn2:
    s_waitcnt lgkmcnt(0)
    s_barrier
    s_branch L_gplaced
.section .rodata,"a"
.p2align 6
.amdhsa_kernel standalone__tensor_product_equiv_equiformer__graph_kernel
  .amdhsa_next_free_vgpr 168
  .amdhsa_next_free_sgpr 102
  .amdhsa_accum_offset 168
  .amdhsa_group_segment_fixed_size 0
  .amdhsa_kernarg_size 96
  .amdhsa_user_sgpr_count 2
  .amdhsa_user_sgpr_kernarg_segment_ptr 1
  .amdhsa_system_sgpr_workgroup_id_x 1
.end_amdhsa_kernel
```
